```python
import torch

def _softmax(x, axis=-1):
    return torch.softmax(x, dim=axis)
def _gelu(x):
    return torch.nn.functional.gelu(x, approximate="tanh")
def _silu(x):
    return torch.nn.functional.silu(x)
def _sigmoid(x):
    return torch.sigmoid(x)
def _layernorm(x, axis=-1, eps=1e-5):
    m = x.mean(dim=axis, keepdim=True)
    v = x.var(dim=axis, keepdim=True, unbiased=False)
    return (x - m) / torch.sqrt(v + eps)
def _scatter_add(tgt, idx, src, axis=0):
    return tgt.clone().index_add_(axis, idx, src)
def _segment_sum(src, seg, n):
    out = torch.zeros((n,) + src.shape[1:], dtype=src.dtype)
    return out.index_add_(0, seg, src)
def _pad(x, pw):
    flat = tuple(v for pair in reversed(pw) for v in pair)
    return torch.nn.functional.pad(x, flat)

kernel_name = 'gated_mix__ssm_conv_s4d__spectral_gfnet__prompt'

def setup_inputs():

    _w = (lambda a: (lambda t: t.to(torch.bfloat16) if t.is_floating_point() else t)(torch.as_tensor(a)))
    def _A_setup():
        Bsz, L, D, N = 1, 2048, 512, 128
        return {
            "u": _w((lambda *s: torch.randn(*s, dtype=torch.bfloat16) * 0.05)(Bsz, L, D)),
            "log_A_real": _w((lambda *s: torch.randn(*s, dtype=torch.bfloat16) * 3.2)(D, N) * 0.5),
            "A_imag": _w((lambda *s: torch.randn(*s, dtype=torch.bfloat16) * 0.05)(D, N) * 3.14),
            "C_real": _w((lambda *s: torch.randn(*s, dtype=torch.bfloat16) * 0.1)(D, N) / N ** 0.5),
            "C_imag": _w((lambda *s: torch.randn(*s, dtype=torch.bfloat16) * 0.1)(D, N) / N ** 0.5),
            "log_dt": _w((lambda *s: torch.randn(*s, dtype=torch.bfloat16) * 0.05)(D) * 0.5 - 4.0),
            "D_skip": _w((lambda *s: torch.randn(*s, dtype=torch.bfloat16) * 0.05)(D)),
        }
    _A_in = _A_setup()

    def _B_setup():
        B, S, D = 1, 2048, 512
        Df = D // 2 + 1
        return {
            "x": _w((lambda *s: torch.randn(*s, dtype=torch.bfloat16) * 0.05)(B, S, D)),
            "w_r": _w((lambda *s: torch.randn(*s, dtype=torch.bfloat16) * 1.6)(S, Df) * 0.02),
            "w_i": _w((lambda *s: torch.randn(*s, dtype=torch.bfloat16) * 1.6)(S, Df) * 0.02),
        }
    _B_in = _B_setup()

    return {
        "A_u": _A_in["u"],
        "A_log_A_real": _A_in["log_A_real"],
        "A_A_imag": _A_in["A_imag"],
        "A_C_real": _A_in["C_real"],
        "A_C_imag": _A_in["C_imag"],
        "A_log_dt": _A_in["log_dt"],
        "A_D_skip": _A_in["D_skip"],
        "B_x": _B_in["x"],
        "B_w_r": _B_in["w_r"],
        "B_w_i": _B_in["w_i"],
        "gate_w": _w((lambda *s: torch.randn(*s, dtype=torch.bfloat16) * 0.05)(512) * 16.0),
    }

def reference(A_u, A_log_A_real, A_A_imag, A_C_real, A_C_imag, A_log_dt, A_D_skip, B_x, B_w_r, B_w_i, gate_w):
    def _A_ref(u, log_A_real, A_imag, C_real, C_imag, log_dt, D_skip):
        L = u.shape[1]
        dt = torch.exp(log_dt)
        A = -torch.exp(log_A_real) + 1j * A_imag
        C = (C_real + 1j * C_imag) * dt[:, None]
        pos = (lambda x, dt: x.to(dt))(torch.arange(L), log_dt.dtype)
        P = torch.exp((A * dt[:, None])[:, :, None] * pos[None, None, :])
        K = 2.0 * torch.einsum("dn,dnl->dl", C, P).real
        L2 = 2 * L
        u_t = (lambda x, *d: x.permute(*d))(u, 0, 2, 1)
        Kf = (lambda x, *a, **k: torch.fft.rfft(x.float(), *a, **k))(K, L2)
        Uf = (lambda x, *a, **k: torch.fft.rfft(x.float(), *a, **k))(u_t, L2)
        y = (lambda x, *a, **k: torch.fft.irfft(x, *a, **k).to(torch.bfloat16))(Uf * Kf[None, :, :], L2)[:, :, :L]
        y = (lambda x, *d: x.permute(*d))(y, 0, 2, 1)
        return y + u * D_skip[None, None, :]

    def _B_ref(x, w_r, w_i):
        B, S, D = x.shape
        X = (lambda x, axes=(-2,-1): torch.fft.rfft2(x.float(), dim=axes))(x, axes=(-2, -1))
        W = w_r + 1j * w_i
        X = X * W
        y = (lambda x, s, axes=(-2,-1): torch.fft.irfft2(x, s=s, dim=axes).to(torch.bfloat16))(X, (S, D), axes=(-2, -1))
        return y

    x = A_u
    g = _sigmoid((x * gate_w).sum(-1, keepdims=True))
    a = _A_ref(x, A_log_A_real, A_A_imag, A_C_real, A_C_imag, A_log_dt, A_D_skip)
    b = _B_ref(x, B_w_r, B_w_i)
    return g * a + (1 - g) * b
```

```asm
; @launch grid=(513,1,1) block=(256,1,1) lds=53760
.amdgcn_target "amdgcn-amd-amdhsa--gfx950"
.text
.globl gated_mix__ssm_conv_s4d__spectral_gfnet__prompt_kernel
.p2align 8
.type gated_mix__ssm_conv_s4d__spectral_gfnet__prompt_kernel,@function
gated_mix__ssm_conv_s4d__spectral_gfnet__prompt_kernel:
    s_load_dwordx2 s[72:73], s[0:1], 0
    s_load_dwordx8 s[12:19], s[0:1], 8
    s_load_dwordx2 s[32:33], s[0:1], 40
    s_load_dwordx2 s[68:69], s[0:1], 48
    s_load_dwordx4 s[44:47], s[0:1], 64
    s_load_dwordx4 s[64:67], s[0:1], 80
    s_load_dwordx2 s[4:5], s[0:1], 104
    s_and_b32 s74, s2, 7
    s_lshl_b32 s74, s74, 5
    s_bfe_u32 s22, s2, 0x50003
    s_add_u32 s74, s74, s22
    s_mov_b32 s34, 0xb40000
    s_cmp_ge_u32 s2, 8
    s_cbranch_scc1 LPF_skip
    s_getpc_b64 s[56:57]
LPF_pc:
    v_mul_u32_u24 v2, 68, v0
    v_min_u32 v2, L_exit-LPF_pc, v2
    v_mov_b32 v3, 0
    v_lshl_add_u64 v[2:3], v[2:3], 0, s[56:57]
    global_load_dword v160, v[2:3], off
LPF_skip:
    s_cmp_ge_u32 s2, 256
    s_cbranch_scc1 L_roleB
    s_mov_b32 s20, s74
    s_lshl_b32 s22, s20, 9
    v_lshl_add_u32 v17, v0, 1, s22
    s_lshl_b32 s23, s20, 2
    v_mov_b32 v8, 0
    v_mov_b32 v9, 0
    v_mov_b32 v10, 0
    v_mov_b32 v11, 0
    s_waitcnt lgkmcnt(0)
    global_load_short_d16_hi v8, v17, s[12:13]
    global_load_short_d16_hi v9, v17, s[14:15]
    global_load_short_d16_hi v10, v17, s[16:17]
    global_load_short_d16_hi v11, v17, s[18:19]
    s_mul_i32 s63, s74, 4112
    v_lshl_add_u32 v163, v0, 4, s63
    global_load_dwordx2 v[160:161], v163, s[44:45]
    global_load_dwordx2 v[160:161], v163, s[46:47]
    s_load_dword s36, s[32:33], s23
    s_load_dword s60, s[4:5], s34
    s_branch L_roleA
L_roleB:
    s_setprio 3
    v_readfirstlane_b32 s21, v0
    s_cmp_ge_u32 s2, 512
    s_cbranch_scc1 L_only2
    s_lshr_b32 s21, s21, 6
    s_and_b32 s23, s2, 7
    s_and_b32 s22, s22, 15
    s_lshl4_add_u32 s23, s23, s22
    s_bfe_u32 s24, s2, 0x10007
    s_bfe_u32 s20, s23, 0x40001
    s_lshl4_add_u32 s20, s24, s20
    s_and_b32 s22, s23, 0x60
    s_add_u32 s20, s20, s22
    s_and_b32 s22, s23, 1
    v_and_b32 v8, 63, v0
    v_lshlrev_b32 v8, 4, v8
    s_and_b32 s29, s21, 1
    s_lshl1_add_u32 s28, s20, s29
    s_lshl_b32 s30, s28, 12
    s_lshr_b32 s29, s21, 1
    s_lshl_b32 s29, s29, 20
    s_add_u32 s30, s30, s29
    s_mul_i32 s31, s21, 4352
    s_waitcnt lgkmcnt(0)
    s_mov_b32 s12, s72
    s_mov_b32 s13, s73
    s_mov_b32 s14, 0x200000
    s_mov_b32 s15, 0x20000
    s_mov_b32 m0, s31
    s_add_u32 s31, s31, 64
    buffer_load_dwordx4 v8, s[12:15], s30 offen offset:0 lds
    s_mov_b32 m0, s31
    s_add_u32 s31, s31, 64
    buffer_load_dwordx4 v8, s[12:15], s30 offen offset:1024 lds
    s_mov_b32 m0, s31
    s_add_u32 s31, s31, 64
    buffer_load_dwordx4 v8, s[12:15], s30 offen offset:2048 lds
    s_mov_b32 m0, s31
    s_add_u32 s31, s31, 64
    buffer_load_dwordx4 v8, s[12:15], s30 offen offset:3072 lds
    s_load_dword s60, s[4:5], s34
    s_mov_b32 s8, s4
    s_mov_b32 s9, s5
    s_mov_b32 s10, 0xb80000
    s_mov_b32 s11, 0x20000
    s_lshl_b32 s63, s21, 8
    s_load_dword s62, s[68:69], s63
    s_load_dword s62, s[64:65], s63
    s_add_u32 s63, s63, 128
    s_load_dword s62, s[68:69], s63
    s_load_dword s62, s[64:65], s63
    v_and_b32 v1, 63, v0
    v_lshrrev_b32 v2, 6, v0
    v_and_b32 v3, 48, v0
    v_readfirstlane_b32 s21, v2
    v_and_b32 v2, 15, v0
    v_lshrrev_b32 v3, 4, v3
    v_lshl_add_u32 v48, v2, 1, s22
    v_cvt_f32_u32 v9, v48
    v_lshlrev_b32 v10, 2, v3
    v_cvt_f32_u32 v10, v10
    v_cvt_f32_u32 v11, v2
    v_mul_f32 v9, 0x3d000000, v9
    v_mul_f32 v12, v9, v10
    v_mov_b32 v14, v12
    v_add_f32 v15, v9, v12
    v_fmamk_f32 v16, v9, 0x40000000, v12
    v_fmamk_f32 v17, v9, 0x40400000, v12
    v_mul_f32 v44, 0x3d800000, v14
    v_mul_f32 v45, 0x3d800000, v15
    v_mul_f32 v46, 0x3d800000, v16
    v_mul_f32 v47, 0x3d800000, v17
    s_setprio 3
    v_cos_f32 v18, v14
    v_cos_f32 v19, v15
    v_cos_f32 v20, v16
    v_cos_f32 v21, v17
    v_sin_f32 v14, v14
    v_sin_f32 v15, v15
    v_sin_f32 v16, v16
    v_sin_f32 v17, v17
    v_cvt_pk_bf16_f32 v24, v18, v19
    v_cvt_pk_bf16_f32 v25, v20, v21
    v_cvt_pk_bf16_f32 v22, -v14, -v15
    v_cvt_pk_bf16_f32 v23, -v16, -v17
    v_cvt_pk_bf16_f32 v26, v14, v15
    v_cvt_pk_bf16_f32 v27, v16, v17
    s_mul_i32 s32, s22, 0x80008000
    v_xor_b32 v28, s32, v22
    v_xor_b32 v29, s32, v23
    v_xor_b32 v30, s32, v24
    v_xor_b32 v31, s32, v25
    v_xor_b32 v32, s32, v26
    v_xor_b32 v33, s32, v27
    v_mul_f32 v11, 0x3d800000, v11
    v_mul_f32 v12, v11, v10
    v_mov_b32 v14, v12
    v_add_f32 v15, v11, v12
    v_fmamk_f32 v16, v11, 0x40000000, v12
    v_fmamk_f32 v17, v11, 0x40400000, v12
    v_cos_f32 v18, v14
    v_cos_f32 v19, v15
    v_cos_f32 v20, v16
    v_cos_f32 v21, v17
    v_sin_f32 v14, v14
    v_sin_f32 v15, v15
    v_sin_f32 v16, v16
    v_sin_f32 v17, v17
    v_cvt_pk_bf16_f32 v36, v18, v19
    v_cvt_pk_bf16_f32 v37, v20, v21
    v_cvt_pk_bf16_f32 v34, -v14, -v15
    v_cvt_pk_bf16_f32 v35, -v16, -v17
    v_cvt_pk_bf16_f32 v38, v14, v15
    v_cvt_pk_bf16_f32 v39, v16, v17
    v_cos_f32 v40, v44
    v_cos_f32 v41, v45
    v_cos_f32 v42, v46
    v_cos_f32 v43, v47
    v_sin_f32 v44, v44
    v_sin_f32 v45, v45
    v_sin_f32 v46, v46
    v_sin_f32 v47, v47
    s_mul_i32 s33, s21, 2176
    v_lshl_add_u32 v49, v1, 3, s33
    v_lshl_add_u32 v58, v3, 7, v48
    v_sub_u32 v59, 1304, v58
    v_cmp_gt_u32 vcc, 2, v3
    s_nop 1
    v_cndmask_b32 v58, v59, v58, vcc
    v_lshrrev_b32 v58, 1, v58
    s_lshl_b32 s34, s21, 2
    s_add_u32 s34, s34, 17408
    v_lshl_add_u32 v50, v58, 4, s34
    v_mov_b32 v58, 256
    v_mov_b32 v59, -256
    v_cndmask_b32 v60, v59, v58, vcc
    v_mov_b32 v58, 2112
    v_mov_b32 v59, -2112
    v_cndmask_b32 v58, v59, v58, vcc
    v_add_u32 v54, v50, v58
    v_add_u32 v51, v50, v60
    v_add_u32 v55, v54, v60
    v_add_u32 v52, v51, v60
    v_add_u32 v56, v55, v60
    v_add_u32 v53, v52, v60
    v_add_u32 v57, v56, v60
    v_and_b32 v58, 3, v0
    v_lshrrev_b32 v59, 2, v0
    v_mul_u32_u24 v61, 2112, v58
    v_sub_u32 v63, 23744, v61
    v_lshl_add_u32 v61, v59, 4, v61
    v_add_u32 v61, 17408, v61
    v_mul_u32_u24 v64, 18176, v59
    v_lshl_add_u32 v64, v58, 4, v64
    s_or_b32 s38, s21, s22
    s_cmp_eq_u32 s38, 0
    s_cselect_b32 vcc_lo, 12, 0
    s_mov_b32 vcc_hi, 0
    s_cselect_b32 s18, 12058624, 0
    s_mov_b32 s16, s8
    s_mov_b32 s17, s9
    s_mov_b32 s19, 0x20000
    v_cndmask_b32 v62, v61, v63, vcc
    v_cndmask_b32 v63, v63, v61, vcc
    s_lshl_b32 s35, s20, 6
    s_mul_i32 s36, s22, 9088
    s_add_u32 s36, s36, s35
    s_add_u32 s38, s36, 1163264
    s_add_u32 s39, s36, 2326528
    v_lshrrev_b32 v59, 2, v2
    v_mul_u32_u24 v65, 1088, v59
    v_lshl_add_u32 v65, v3, 5, v65
    v_lshl_add_u32 v65, v58, 3, v65
    s_lshl_b32 s37, s22, 9
    s_lshl_b32 s40, s21, 7
    s_add_u32 s37, s37, s40
    v_add_u32 v65, s37, v65
    s_mul_i32 s37, s22, 1163264
    s_add_u32 s37, s37, s35
    s_add_u32 s37, s37, 0x480000
    s_add_u32 s40, s37, 9088
    s_waitcnt lgkmcnt(0)
    s_add_u32 s60, s60, 0x10000
    s_and_b32 s60, s60, 0xfffffee8
    s_or_b32 s60, s60, 1
    s_mov_b32 s61, 0x00010001
    v_lshlrev_b32 v7, 2, v0
    v_and_b32 v7, 12, v7
    v_lshrrev_b32 v7, v7, s60
    v_and_b32 v4, s61, v7
    v_lshrrev_b32 v5, 1, v7
    v_and_b32 v5, s61, v5
    v_lshrrev_b32 v6, 2, v7
    v_and_b32 v6, s61, v6
    v_lshrrev_b32 v7, 3, v7
    v_and_b32 v7, s61, v7
    s_mov_b32 vcc_lo, 0x33333333
    s_mov_b32 vcc_hi, 0x33333333
    s_setprio 3
    s_and_b32 s52, s2, 7
    s_bfe_u32 s53, s2, 0x10003
    s_bfe_u32 s54, s2, 0x20004
    s_bfe_u32 s55, s2, 0x20006
    s_lshl_b32 s56, s55, 3
    s_add_u32 s56, s56, s54
    s_lshl_b32 s57, s52, 8
    s_add_u32 s56, s56, s57
    s_lshl_b32 s70, s55, 11
    s_add_u32 s70, s70, s57
    s_lshl_b32 s71, s54, 6
    s_add_u32 s70, s70, s71
    s_add_u32 s70, s70, 0x240000
    s_and_b32 s54, s54, 1
    s_lshl_b32 s71, s53, 7
    s_lshl_b32 s57, s21, 5
    s_add_u32 s71, s71, s57
    s_add_u32 s71, s71, s54
    v_and_b32 v102, 1, v1
    v_lshlrev_b32 v101, 5, v102
    v_and_b32 v102, 2, v1
    v_lshl_add_u32 v101, v102, 1, v101
    v_add_u32 v101, s56, v101
    v_lshl_add_u32 v100, v3, 6, v101
    v_mul_u32_u24 v100, 514, v100
    v_lshrrev_b32 v102, 2, v2
    v_lshl_add_u32 v100, v102, 4, v100
    s_lshl_b32 s57, s71, 1
    s_mov_b32 s48, s46
    s_mov_b32 s49, s47
    s_mov_b32 s46, 0x101000
    s_mov_b32 s47, 0x20000
    s_mov_b32 s50, 0x101000
    s_mov_b32 s51, 0x20000
    buffer_load_dwordx4 v[148:151], v100, s[44:47], s57 offen
    buffer_load_dwordx4 v[152:155], v100, s[48:51], s57 offen
    v_lshl_add_u32 v101, v102, 6, v101
    v_lshl_add_u32 v102, v102, 3, v3
    v_lshlrev_b32 v163, 4, v1
    v_and_b32 v163, 48, v163
    v_mul_u32_u24 v102, 9088, v102
    v_add_u32 v163, v102, v163
    s_mul_i32 s71, s71, 9088
    s_add_u32 s71, s71, s70
    v_sub_u32 v100, 2048, v101
    v_and_b32 v100, 2047, v100
    v_mul_u32_u24 v100, 514, v100
    v_mul_u32_u24 v101, 514, v101
    s_lshl_b32 s57, s53, 9
    s_cmp_eq_u32 s21, 3
    s_cselect_b32 s46, s46, 0
    s_cselect_b32 s50, s50, 0
    s_mov_b64 exec, 0xffff
    buffer_load_ushort v156, v101, s[44:47], s57 offen
    buffer_load_ushort v160, v100, s[44:47], s57 offen
    buffer_load_ushort v161, v101, s[48:51], s57 offen
    buffer_load_ushort v162, v100, s[48:51], s57 offen
    s_mov_b64 exec, -1
    s_add_u32 s53, s53, 257
    s_mul_i32 s53, s53, 9088
    s_add_u32 s70, s70, s53
    s_mov_b32 vcc_lo, 0x33333333
    s_mov_b32 vcc_hi, 0x33333333
    s_waitcnt vmcnt(6)
    s_barrier
    ds_read_b64_tr_b16 v[68:69], v49 offset:0
    ds_read_b64_tr_b16 v[70:71], v49 offset:8704
    ds_read_b64_tr_b16 v[72:73], v49 offset:512
    ds_read_b64_tr_b16 v[74:75], v49 offset:9216
    ds_read_b64_tr_b16 v[76:77], v49 offset:1088
    ds_read_b64_tr_b16 v[78:79], v49 offset:9792
    ds_read_b64_tr_b16 v[80:81], v49 offset:1600
    ds_read_b64_tr_b16 v[82:83], v49 offset:10304
    ds_read_b64_tr_b16 v[100:101], v65 offset:0
    ds_read_b64_tr_b16 v[102:103], v65 offset:4352
    ds_read_b64_tr_b16 v[104:105], v65 offset:8704
    ds_read_b64_tr_b16 v[106:107], v65 offset:13056
    s_waitcnt lgkmcnt(10)
    v_mfma_f32_16x16x32_bf16 v[84:87], v[68:71], v[24:27], 0
    v_mfma_f32_16x16x32_bf16 v[92:95], v[68:71], v[22:25], 0
    s_waitcnt lgkmcnt(8)
    v_mfma_f32_16x16x32_bf16 v[84:87], v[72:75], v[30:33], v[84:87]
    v_mfma_f32_16x16x32_bf16 v[92:95], v[72:75], v[28:31], v[92:95]
    s_waitcnt lgkmcnt(6)
    v_mfma_f32_16x16x32_bf16 v[88:91], v[76:79], v[24:27], 0
    v_mfma_f32_16x16x32_bf16 v[96:99], v[76:79], v[22:25], 0
    s_waitcnt lgkmcnt(4)
    v_mfma_f32_16x16x32_bf16 v[88:91], v[80:83], v[30:33], v[88:91]
    v_mfma_f32_16x16x32_bf16 v[96:99], v[80:83], v[28:31], v[96:99]
    s_waitcnt lgkmcnt(0)
    v_cndmask_b32_dpp v68, v104, v100, vcc quad_perm:[0,1,0,1] row_mask:0xf bank_mask:0xf
    v_cndmask_b32_dpp v69, v105, v101, vcc quad_perm:[0,1,0,1] row_mask:0xf bank_mask:0xf
    v_cndmask_b32_dpp v70, v106, v102, vcc quad_perm:[0,1,0,1] row_mask:0xf bank_mask:0xf
    v_cndmask_b32_dpp v71, v107, v103, vcc quad_perm:[0,1,0,1] row_mask:0xf bank_mask:0xf
    s_not_b64 vcc, vcc
    v_bfi_b32 v68, s61, v4, v68
    v_bfi_b32 v69, s61, v5, v69
    v_bfi_b32 v70, s61, v6, v70
    v_bfi_b32 v71, s61, v7, v71
    buffer_store_dwordx4 v[68:71], v64, s[8:11], s37 offen sc0 sc1
    v_pk_mul_f32 v[14:15], v[92:93], v[44:45]
    v_pk_mul_f32 v[18:19], v[84:85], v[44:45]
    v_pk_mul_f32 v[16:17], v[94:95], v[46:47]
    v_pk_mul_f32 v[20:21], v[86:87], v[46:47]
    v_pk_fma_f32 v[84:85], v[84:85], v[40:41], v[14:15]
    v_pk_fma_f32 v[92:93], v[92:93], v[40:41], v[18:19] neg_lo:[0,0,1] neg_hi:[0,0,1]
    v_pk_fma_f32 v[86:87], v[86:87], v[42:43], v[16:17]
    v_pk_fma_f32 v[94:95], v[94:95], v[42:43], v[20:21] neg_lo:[0,0,1] neg_hi:[0,0,1]
    v_cvt_pk_bf16_f32 v72, v84, v85
    v_cvt_pk_bf16_f32 v73, v86, v87
    v_cvt_pk_bf16_f32 v74, v92, v93
    v_cvt_pk_bf16_f32 v75, v94, v95
    v_pk_mul_f32 v[14:15], v[96:97], v[44:45]
    v_pk_mul_f32 v[18:19], v[88:89], v[44:45]
    v_pk_mul_f32 v[16:17], v[98:99], v[46:47]
    v_pk_mul_f32 v[20:21], v[90:91], v[46:47]
    v_pk_fma_f32 v[88:89], v[88:89], v[40:41], v[14:15]
    v_pk_fma_f32 v[96:97], v[96:97], v[40:41], v[18:19] neg_lo:[0,0,1] neg_hi:[0,0,1]
    v_pk_fma_f32 v[90:91], v[90:91], v[42:43], v[16:17]
    v_pk_fma_f32 v[98:99], v[98:99], v[42:43], v[20:21] neg_lo:[0,0,1] neg_hi:[0,0,1]
    v_cvt_pk_bf16_f32 v80, v88, v89
    v_cvt_pk_bf16_f32 v81, v90, v91
    v_cvt_pk_bf16_f32 v82, v96, v97
    v_cvt_pk_bf16_f32 v83, v98, v99
    v_mfma_f32_16x16x32_bf16 v[84:87], v[36:39], v[72:75], 0
    s_nop 0
    v_mfma_f32_16x16x32_bf16 v[88:91], v[36:39], v[80:83], 0
    v_mfma_f32_16x16x32_bf16 v[92:95], v[34:37], v[72:75], 0
    v_mfma_f32_16x16x32_bf16 v[96:99], v[34:37], v[80:83], 0
    v_cndmask_b32_dpp v76, v100, v104, vcc quad_perm:[2,3,2,3] row_mask:0xf bank_mask:0xf
    v_cndmask_b32_dpp v77, v101, v105, vcc quad_perm:[2,3,2,3] row_mask:0xf bank_mask:0xf
    v_cndmask_b32_dpp v78, v102, v106, vcc quad_perm:[2,3,2,3] row_mask:0xf bank_mask:0xf
    v_cndmask_b32_dpp v79, v103, v107, vcc quad_perm:[2,3,2,3] row_mask:0xf bank_mask:0xf
    v_bfi_b32 v76, s61, v4, v76
    v_bfi_b32 v77, s61, v5, v77
    v_bfi_b32 v78, s61, v6, v78
    v_bfi_b32 v79, s61, v7, v79
    buffer_store_dwordx4 v[76:79], v64, s[8:11], s40 offen sc0 sc1
    v_cvt_pk_bf16_f32 v14, v84, v88
    v_cvt_pk_bf16_f32 v15, v85, v89
    v_cvt_pk_bf16_f32 v16, v86, v90
    v_cvt_pk_bf16_f32 v17, v87, v91
    ds_write_b32 v50, v14
    ds_write_b32 v51, v15
    ds_write_b32 v52, v16
    ds_write_b32 v53, v17
    v_cvt_pk_bf16_f32 v18, v92, v96
    v_cvt_pk_bf16_f32 v19, v93, v97
    v_cvt_pk_bf16_f32 v20, v94, v98
    v_cvt_pk_bf16_f32 v21, v95, v99
    ds_write_b32 v54, v18
    ds_write_b32 v55, v19
    ds_write_b32 v56, v20
    ds_write_b32 v57, v21
    s_waitcnt lgkmcnt(0)
    s_barrier
    ds_read_b128 v[68:71], v62
    ds_read_b128 v[76:79], v61 offset:1024
    ds_read_b128 v[100:103], v63 offset:2048
    s_waitcnt lgkmcnt(2)
    v_bfi_b32 v68, s61, v4, v68
    v_bfi_b32 v69, s61, v5, v69
    v_bfi_b32 v70, s61, v6, v70
    v_bfi_b32 v71, s61, v7, v71
    buffer_store_dwordx4 v[68:71], v64, s[8:11], s36 offen sc0 sc1
    s_waitcnt lgkmcnt(1)
    v_bfi_b32 v76, s61, v4, v76
    v_bfi_b32 v77, s61, v5, v77
    v_bfi_b32 v78, s61, v6, v78
    v_bfi_b32 v79, s61, v7, v79
    buffer_store_dwordx4 v[76:79], v64, s[8:11], s38 offen sc0 sc1
    s_waitcnt lgkmcnt(0)
    v_bfi_b32 v100, s61, v4, v100
    v_bfi_b32 v101, s61, v5, v101
    v_bfi_b32 v102, s61, v6, v102
    v_bfi_b32 v103, s61, v7, v103
    s_mov_b64 exec, 15
    buffer_store_dwordx4 v[100:103], v64, s[16:19], s39 offen sc0 sc1
    s_mov_b64 exec, -1
    s_mov_b32 s52, 0x05040100
    s_mov_b32 s53, 0x07060302
    s_waitcnt vmcnt(5)
    v_perm_b32 v84, v152, v148, s52
    v_perm_b32 v85, v152, v148, s53
    v_perm_b32 v86, v153, v149, s52
    v_perm_b32 v87, v153, v149, s53
    v_perm_b32 v88, v154, v150, s52
    v_perm_b32 v89, v154, v150, s53
    v_perm_b32 v90, v155, v151, s52
    v_perm_b32 v91, v155, v151, s53
    v_permlane32_swap_b32 v84, v86
    v_permlane32_swap_b32 v85, v87
    v_permlane32_swap_b32 v88, v90
    v_permlane32_swap_b32 v89, v91
    v_permlane16_swap_b32 v84, v85
    v_permlane16_swap_b32 v86, v87
    v_permlane16_swap_b32 v88, v89
    v_permlane16_swap_b32 v90, v91
    v_bfi_b32 v84, s61, v4, v84
    v_bfi_b32 v85, s61, v5, v85
    v_bfi_b32 v86, s61, v6, v86
    v_bfi_b32 v87, s61, v7, v87
    buffer_store_dwordx4 v[84:87], v163, s[8:11], s71 offen sc0 sc1
    s_add_u32 s71, s71, 36352
    v_bfi_b32 v88, s61, v4, v88
    v_bfi_b32 v89, s61, v5, v89
    v_bfi_b32 v90, s61, v6, v90
    v_bfi_b32 v91, s61, v7, v91
    buffer_store_dwordx4 v[88:91], v163, s[8:11], s71 offen sc0 sc1
    s_cmp_lg_u32 s21, 3
    s_cbranch_scc1 LW_done
    v_lshlrev_b32 v156, 16, v156
    v_lshlrev_b32 v160, 16, v160
    v_lshlrev_b32 v161, 16, v161
    v_lshlrev_b32 v162, 16, v162
    v_add_f32 v156, v156, v160
    v_sub_f32 v161, v161, v162
    v_mul_f32 v156, 0.5, v156
    v_mul_f32 v161, 0.5, v161
    v_cvt_pk_bf16_f32 v156, v156, v161
    s_nop 1
    v_mov_b32_dpp v157, v156 row_shl:4 row_mask:0xf bank_mask:0xf bound_ctrl:1
    v_mov_b32_dpp v158, v156 row_shl:8 row_mask:0xf bank_mask:0xf bound_ctrl:1
    v_mov_b32_dpp v159, v156 row_shl:12 row_mask:0xf bank_mask:0xf bound_ctrl:1
    v_bfi_b32 v156, s61, v4, v156
    v_bfi_b32 v157, s61, v5, v157
    v_bfi_b32 v158, s61, v6, v158
    v_bfi_b32 v159, s61, v7, v159
    s_mov_b64 exec, 15
    buffer_store_dwordx4 v[156:159], v163, s[8:11], s70 offen sc0 sc1
    s_mov_b64 exec, -1
LW_done:
    s_setprio 1
L_consts:
    v_lshlrev_b32 v34, 4, v1
    v_lshrrev_b32 v53, 2, v2
    v_lshlrev_b32 v57, 31, v53
    v_and_b32 v52, 2, v2
    v_lshl_add_u32 v53, v52, 1, v53
    v_and_b32 v52, 1, v2
    v_lshl_add_u32 v53, v52, 5, v53
    s_lshl_b32 s63, s21, 3
    v_add_u32 v53, s63, v53
    v_cvt_f32_u32 v54, v53
    v_cvt_f32_u32 v55, v3
    v_mul_f32 v54, 0x3c800000, v54
    v_mul_f32 v56, v54, v55
    v_xor_b32 v58, 0x80008000, v57
    v_mov_b32 v44, v56
    v_fmamk_f32 v45, v54, 0x40800000, v56
    v_fmamk_f32 v46, v54, 0x41000000, v56
    v_fmamk_f32 v47, v54, 0x41400000, v56
    v_cos_f32 v48, v44
    v_cos_f32 v49, v45
    v_cos_f32 v50, v46
    v_cos_f32 v51, v47
    v_sin_f32 v44, v44
    v_sin_f32 v45, v45
    v_sin_f32 v46, v46
    v_sin_f32 v47, v47
    v_cvt_pk_bf16_f32 v48, v48, v48
    v_cvt_pk_bf16_f32 v44, v44, v44
    v_cvt_pk_bf16_f32 v49, v49, v49
    v_cvt_pk_bf16_f32 v45, v45, v45
    v_cvt_pk_bf16_f32 v50, v50, v50
    v_cvt_pk_bf16_f32 v46, v46, v46
    v_cvt_pk_bf16_f32 v51, v51, v51
    v_cvt_pk_bf16_f32 v47, v47, v47
    v_xor_b32 v110, v57, v48
    v_xor_b32 v108, v58, v44
    v_xor_b32 v112, v57, v44
    v_xor_b32 v111, v57, v49
    v_xor_b32 v109, v58, v45
    v_xor_b32 v113, v57, v45
    v_xor_b32 v116, v57, v50
    v_xor_b32 v114, v58, v46
    v_xor_b32 v118, v57, v46
    v_xor_b32 v117, v57, v51
    v_xor_b32 v115, v58, v47
    v_xor_b32 v119, v57, v47
    v_fmamk_f32 v44, v54, 0x41800000, v56
    v_fmamk_f32 v45, v54, 0x41a00000, v56
    v_fmamk_f32 v46, v54, 0x41c00000, v56
    v_fmamk_f32 v47, v54, 0x41e00000, v56
    v_cos_f32 v48, v44
    v_cos_f32 v49, v45
    v_cos_f32 v50, v46
    v_cos_f32 v51, v47
    v_sin_f32 v44, v44
    v_sin_f32 v45, v45
    v_sin_f32 v46, v46
    v_sin_f32 v47, v47
    v_cvt_pk_bf16_f32 v48, v48, v48
    v_cvt_pk_bf16_f32 v44, v44, v44
    v_cvt_pk_bf16_f32 v49, v49, v49
    v_cvt_pk_bf16_f32 v45, v45, v45
    v_cvt_pk_bf16_f32 v50, v50, v50
    v_cvt_pk_bf16_f32 v46, v46, v46
    v_cvt_pk_bf16_f32 v51, v51, v51
    v_cvt_pk_bf16_f32 v47, v47, v47
    v_xor_b32 v122, v57, v48
    v_xor_b32 v120, v58, v44
    v_xor_b32 v124, v57, v44
    v_xor_b32 v123, v57, v49
    v_xor_b32 v121, v58, v45
    v_xor_b32 v125, v57, v45
    v_xor_b32 v128, v57, v50
    v_xor_b32 v126, v58, v46
    v_xor_b32 v130, v57, v46
    v_xor_b32 v129, v57, v51
    v_xor_b32 v127, v58, v47
    v_xor_b32 v131, v57, v47
    v_mul_f32 v54, 0x3d000000, v54
    v_mul_f32 v56, 0x3e000000, v56
    v_mov_b32 v140, v56
    v_add_f32 v141, v54, v56
    v_fmamk_f32 v142, v54, 0x40000000, v56
    v_fmamk_f32 v143, v54, 0x40400000, v56
    v_cos_f32 v132, v140
    v_cos_f32 v133, v141
    v_cos_f32 v134, v142
    v_cos_f32 v135, v143
    v_sin_f32 v140, v140
    v_sin_f32 v141, v141
    v_sin_f32 v142, v142
    v_sin_f32 v143, v143
    v_fmamk_f32 v144, v54, 0x41800000, v56
    v_fmamk_f32 v145, v54, 0x41880000, v56
    v_fmamk_f32 v146, v54, 0x41900000, v56
    v_fmamk_f32 v147, v54, 0x41980000, v56
    v_cos_f32 v136, v144
    v_cos_f32 v137, v145
    v_cos_f32 v138, v146
    v_cos_f32 v139, v147
    v_sin_f32 v144, v144
    v_sin_f32 v145, v145
    v_sin_f32 v146, v146
    v_sin_f32 v147, v147
    s_lshl_b32 s28, s21, 3
    v_cvt_f32_u32 v37, v3
    s_mul_i32 s22, s74, 9088
    s_lshl_b32 s25, s21, 11
    s_add_u32 s22, s22, s25
    v_bfe_u32 v32, v1, 3, 1
    v_lshlrev_b32 v41, 12, v32
    v_lshl_add_u32 v41, v3, 7, v41
    v_and_b32 v32, 7, v1
    v_lshl_add_u32 v41, v32, 4, v41
    s_lshl_b32 s29, s21, 10
    s_add_u32 s30, s29, 26624
    v_add_u32 v41, s30, v41
    v_lshrrev_b32 v32, 3, v2
    v_lshl_add_u32 v42, v32, 2, v3
    v_lshlrev_b32 v42, 7, v42
    v_lshl_add_u32 v42, v32, 4, v42
    v_and_b32 v32, 4, v2
    v_lshl_add_u32 v42, v32, 3, v42
    v_and_b32 v32, 2, v2
    v_lshl_add_u32 v42, v32, 5, v42
    v_and_b32 v32, 1, v2
    v_lshl_add_u32 v42, v32, 3, v42
    v_xor_b32 v43, 16, v42
    s_and_b32 s26, s74, 255
    s_lshr_b32 s27, s74, 8
    s_add_u32 s27, s27, 257
    s_cmp_eq_u32 s26, 0
    s_cselect_b32 s26, s27, s74
    s_mul_i32 s26, s26, 9088
    s_add_u32 s26, s26, s25
    s_add_u32 s26, s26, 0x240000
    v_cvt_f32_u32 v35, v2
    v_mul_f32 v36, 0x3d000000, v35
    v_mul_f32 v38, v36, v37
    v_mul_f32 v38, 4.0, v38
    v_mov_b32 v100, v38
    v_add_f32 v101, v36, v38
    v_fmamk_f32 v102, v36, 0x40000000, v38
    v_fmamk_f32 v103, v36, 0x40400000, v38
    v_cos_f32 v104, v100
    v_cos_f32 v105, v101
    v_cos_f32 v106, v102
    v_cos_f32 v107, v103
    v_sin_f32 v100, v100
    v_sin_f32 v101, v101
    v_sin_f32 v102, v102
    v_sin_f32 v103, v103
    v_cvt_pk_bf16_f32 v10, v104, v105
    v_cvt_pk_bf16_f32 v11, v106, v107
    v_cvt_pk_bf16_f32 v8, -v100, -v101
    v_cvt_pk_bf16_f32 v9, -v102, -v103
    v_cvt_pk_bf16_f32 v12, v100, v101
    v_cvt_pk_bf16_f32 v13, v102, v103
    v_and_b32 v39, 1, v2
    v_mul_u32_u24 v39, 0x8000, v39
    v_lshl_or_b32 v39, v39, 16, v39
    v_xor_b32 v40, 0x80000000, v39
    v_xor_b32 v14, v39, v8
    v_xor_b32 v20, 0x80000000, v8
    v_xor_b32 v26, v40, v8
    v_xor_b32 v15, v39, v9
    v_xor_b32 v21, 0x80000000, v9
    v_xor_b32 v27, v40, v9
    v_xor_b32 v16, v39, v10
    v_xor_b32 v22, 0x80000000, v10
    v_xor_b32 v28, v40, v10
    v_xor_b32 v17, v39, v11
    v_xor_b32 v23, 0x80000000, v11
    v_xor_b32 v29, v40, v11
    v_xor_b32 v18, v39, v12
    v_xor_b32 v24, 0x80000000, v12
    v_xor_b32 v30, v40, v12
    v_xor_b32 v19, v39, v13
    v_xor_b32 v25, 0x80000000, v13
    v_xor_b32 v31, v40, v13
    v_add_u32 v32, s28, v3
    v_cvt_f32_u32 v32, v32
    v_mul_f32 v36, 0x3a000000, v35
    v_add_f32 v37, 0x3c000000, v36
    v_mul_f32 v38, v36, v32
    v_mul_f32 v39, v37, v32
    v_mov_b32 v156, v38
    v_fmamk_f32 v157, v36, 0x42000000, v38
    v_fmamk_f32 v158, v36, 0x40800000, v38
    v_fmamk_f32 v159, v36, 0x42100000, v38
    v_cos_f32 v148, v156
    v_cos_f32 v149, v157
    v_cos_f32 v150, v158
    v_cos_f32 v151, v159
    v_sin_f32 v156, v156
    v_sin_f32 v157, v157
    v_sin_f32 v158, v158
    v_sin_f32 v159, v159
    v_mov_b32 v160, v39
    v_fmamk_f32 v161, v37, 0x42000000, v39
    v_fmamk_f32 v162, v37, 0x40800000, v39
    v_fmamk_f32 v163, v37, 0x42100000, v39
    v_cos_f32 v152, v160
    v_cos_f32 v153, v161
    v_cos_f32 v154, v162
    v_cos_f32 v155, v163
    v_sin_f32 v160, v160
    v_sin_f32 v161, v161
    v_sin_f32 v162, v162
    v_sin_f32 v163, v163
    v_add_u32 v35, s29, v34
    v_lshrrev_b32 v32, 2, v2
    v_lshl_add_u32 v32, v32, 3, v3
    v_mul_u32_u24 v40, 16512, v32
    v_and_b32 v32, 3, v2
    v_lshl_add_u32 v40, v32, 4, v40
    s_mul_i32 s30, s21, 528384
    s_lshl_b32 s33, s74, 6
    s_add_u32 s30, s30, s33
    s_add_u32 s30, s30, 0x6c0000
    s_add_u32 s33, s30, 66048
    v_xor_b32 v33, 16, v41
    v_lshlrev_b32 v36, 8, v3
    v_lshl_add_u32 v36, v2, 2, v36
    s_lshl_b32 s31, s20, 3
    s_and_b32 s32, s23, 1
    s_lshl_b32 s32, s32, 2
    s_add_u32 s32, s32, s21
    s_add_u32 s31, s31, s32
    s_lshl_b32 s41, s31, 10
    s_add_u32 s42, s41, 1048576
    s_setprio 3
    s_cmp_eq_u32 s74, 256
    s_cbranch_scc1 LB_lowprio
    s_setprio 3
LB_lowprio:
    s_mov_b32 s62, 0
    s_mov_b64 vcc, -1
LP1:
LP1_e:
    s_wqm_b64 exec, vcc
    buffer_load_dwordx4 v[44:47], v34, s[8:11], s22 offen offset:0 sc0 sc1
    buffer_load_dwordx4 v[48:51], v34, s[8:11], s22 offen offset:1024 sc0 sc1
LP1_w:
    s_waitcnt vmcnt(0)
    v_xor_b32 v44, v4, v44
    v_xor_b32 v45, v5, v45
    v_xor_b32 v46, v6, v46
    v_xor_b32 v47, v7, v47
    v_xor_b32 v48, v4, v48
    v_xor_b32 v49, v5, v49
    v_xor_b32 v50, v6, v50
    v_xor_b32 v51, v7, v51
    v_or3_b32 v32, v44, v45, v46
    v_or3_b32 v32, v32, v47, v48
    v_or3_b32 v32, v32, v49, v50
    v_or_b32 v32, v32, v51
    v_and_b32 v32, s61, v32
    v_cmp_ne_u32 vcc, 0, v32
    s_add_u32 s62, s62, 1
    s_cmp_lt_u32 s62, 65536
    s_cselect_b64 vcc, vcc, 0
    s_cbranch_vccnz LP1
    s_mov_b64 exec, -1
    ds_write_b128 v41, v[44:47]
    ds_write_b128 v33, v[48:51] offset:512
    s_waitcnt lgkmcnt(0)
    s_barrier
    ds_read_b64_tr_b16 v[44:45], v42 offset:26624
    ds_read_b64_tr_b16 v[46:47], v43 offset:26624
    ds_read_b64_tr_b16 v[48:49], v42 offset:27648
    ds_read_b64_tr_b16 v[50:51], v43 offset:27648
    ds_read_b64_tr_b16 v[52:53], v42 offset:28672
    ds_read_b64_tr_b16 v[54:55], v43 offset:28672
    ds_read_b64_tr_b16 v[56:57], v42 offset:29696
    ds_read_b64_tr_b16 v[58:59], v43 offset:29696
    ds_read_b64_tr_b16 v[60:61], v42 offset:30720
    ds_read_b64_tr_b16 v[62:63], v43 offset:30720
    ds_read_b64_tr_b16 v[64:65], v42 offset:31744
    ds_read_b64_tr_b16 v[66:67], v43 offset:31744
    ds_read_b64_tr_b16 v[68:69], v42 offset:32768
    ds_read_b64_tr_b16 v[70:71], v43 offset:32768
    ds_read_b64_tr_b16 v[72:73], v42 offset:33792
    ds_read_b64_tr_b16 v[74:75], v43 offset:33792
    s_waitcnt lgkmcnt(14)
    v_mfma_f32_16x16x32_bf16 v[76:79], v[44:47], v[110:113], 0
    v_mfma_f32_16x16x32_bf16 v[84:87], v[44:47], v[108:111], 0
    s_waitcnt lgkmcnt(12)
    v_mfma_f32_16x16x32_bf16 v[76:79], v[48:51], v[116:119], v[76:79]
    v_mfma_f32_16x16x32_bf16 v[84:87], v[48:51], v[114:117], v[84:87]
    s_waitcnt lgkmcnt(10)
    v_mfma_f32_16x16x32_bf16 v[76:79], v[52:55], v[122:125], v[76:79]
    v_mfma_f32_16x16x32_bf16 v[84:87], v[52:55], v[120:123], v[84:87]
    s_waitcnt lgkmcnt(8)
    v_mfma_f32_16x16x32_bf16 v[76:79], v[56:59], v[128:131], v[76:79]
    v_mfma_f32_16x16x32_bf16 v[84:87], v[56:59], v[126:129], v[84:87]
    s_waitcnt lgkmcnt(6)
    v_mfma_f32_16x16x32_bf16 v[80:83], v[60:63], v[110:113], 0
    v_mfma_f32_16x16x32_bf16 v[88:91], v[60:63], v[108:111], 0
    s_waitcnt lgkmcnt(4)
    v_mfma_f32_16x16x32_bf16 v[80:83], v[64:67], v[116:119], v[80:83]
    v_mfma_f32_16x16x32_bf16 v[88:91], v[64:67], v[114:117], v[88:91]
    s_nop 0
    v_mul_f32 v100, v76, v132
    v_mul_f32 v104, v84, v132
    v_mul_f32 v101, v77, v133
    s_waitcnt lgkmcnt(2)
    v_mfma_f32_16x16x32_bf16 v[80:83], v[68:71], v[122:125], v[80:83]
    v_mul_f32 v105, v85, v133
    v_mul_f32 v102, v78, v134
    v_mul_f32 v106, v86, v134
    v_mfma_f32_16x16x32_bf16 v[88:91], v[68:71], v[120:123], v[88:91]
    v_mul_f32 v103, v79, v135
    v_mul_f32 v107, v87, v135
    v_fmac_f32 v100, v84, v140
    s_waitcnt lgkmcnt(0)
    v_mfma_f32_16x16x32_bf16 v[80:83], v[72:75], v[128:131], v[80:83]
    v_fma_f32 v104, -v76, v140, v104
    v_fmac_f32 v101, v85, v141
    v_fma_f32 v105, -v77, v141, v105
    v_mfma_f32_16x16x32_bf16 v[88:91], v[72:75], v[126:129], v[88:91]
    v_fmac_f32 v102, v86, v142
    v_fma_f32 v106, -v78, v142, v106
    v_fmac_f32 v103, v87, v143
    v_fma_f32 v107, -v79, v143, v107
    v_cvt_pk_bf16_f32 v44, v100, v101
    v_cvt_pk_bf16_f32 v45, v102, v103
    v_cvt_pk_bf16_f32 v46, v104, v105
    v_cvt_pk_bf16_f32 v47, v106, v107
    buffer_load_dwordx4 v[92:95], v34, s[8:11], s26 offen offset:0 sc0 sc1
    buffer_load_dwordx4 v[96:99], v34, s[8:11], s26 offen offset:1024 sc0 sc1
    v_mfma_f32_16x16x32_bf16 v[60:63], v[10:13], v[44:47], 0
    v_mul_f32 v100, v80, v136
    v_mul_f32 v104, v88, v136
    v_mul_f32 v101, v81, v137
    v_mfma_f32_16x16x32_bf16 v[68:71], v[8:11], v[44:47], 0
    v_mul_f32 v105, v89, v137
    v_mul_f32 v102, v82, v138
    v_mul_f32 v106, v90, v138
    v_mfma_f32_16x16x32_bf16 v[64:67], v[22:25], v[44:47], 0
    v_mul_f32 v103, v83, v139
    v_mul_f32 v107, v91, v139
    v_fmac_f32 v100, v88, v144
    v_mfma_f32_16x16x32_bf16 v[72:75], v[20:23], v[44:47], 0
    v_fma_f32 v104, -v80, v144, v104
    v_fmac_f32 v101, v89, v145
    v_fma_f32 v105, -v81, v145, v105
    v_fmac_f32 v102, v90, v146
    v_fma_f32 v106, -v82, v146, v106
    v_fmac_f32 v103, v91, v147
    v_fma_f32 v107, -v83, v147, v107
    v_cvt_pk_bf16_f32 v48, v100, v101
    v_cvt_pk_bf16_f32 v49, v102, v103
    v_cvt_pk_bf16_f32 v50, v104, v105
    v_cvt_pk_bf16_f32 v51, v106, v107
    s_nop 1
    v_mfma_f32_16x16x32_bf16 v[60:63], v[16:19], v[48:51], v[60:63]
    v_mfma_f32_16x16x32_bf16 v[68:71], v[14:17], v[48:51], v[68:71]
    v_mfma_f32_16x16x32_bf16 v[64:67], v[28:31], v[48:51], v[64:67]
    v_mfma_f32_16x16x32_bf16 v[72:75], v[26:29], v[48:51], v[72:75]
    s_mov_b32 s62, 0
    s_waitcnt vmcnt(0)
    v_xor_b32 v92, v4, v92
    v_xor_b32 v93, v5, v93
    v_xor_b32 v94, v6, v94
    v_xor_b32 v95, v7, v95
    v_xor_b32 v96, v4, v96
    v_xor_b32 v97, v5, v97
    v_xor_b32 v98, v6, v98
    v_xor_b32 v99, v7, v99
    v_or3_b32 v32, v92, v93, v94
    v_or3_b32 v32, v32, v95, v96
    v_or3_b32 v32, v32, v97, v98
    v_or_b32 v32, v32, v99
    v_and_b32 v32, s61, v32
    v_cmp_ne_u32 vcc, 0, v32
    s_nop 0
    s_cbranch_vccnz LP2
LP2_ok:
    v_lshlrev_b32 v132, 16, v92
    v_and_b32 v140, 0xffff0000, v92
    v_lshlrev_b32 v133, 16, v93
    v_and_b32 v141, 0xffff0000, v93
    v_lshlrev_b32 v134, 16, v94
    v_and_b32 v142, 0xffff0000, v94
    v_lshlrev_b32 v135, 16, v95
    v_and_b32 v143, 0xffff0000, v95
    v_mul_f32 v100, v60, v132
    v_mul_f32 v104, v68, v132
    v_mul_f32 v101, v61, v133
    v_mul_f32 v105, v69, v133
    v_mul_f32 v102, v62, v134
    v_mul_f32 v106, v70, v134
    v_mul_f32 v103, v63, v135
    v_mul_f32 v107, v71, v135
    v_fma_f32 v100, -v68, v140, v100
    v_fmac_f32 v104, v60, v140
    v_fma_f32 v101, -v69, v141, v101
    v_fmac_f32 v105, v61, v141
    v_fma_f32 v102, -v70, v142, v102
    v_fmac_f32 v106, v62, v142
    v_fma_f32 v103, -v71, v143, v103
    v_fmac_f32 v107, v63, v143
    v_cvt_pk_bf16_f32 v52, v104, v105
    v_cvt_pk_bf16_f32 v53, v106, v107
    v_cvt_pk_bf16_f32 v54, v100, v101
    v_cvt_pk_bf16_f32 v55, v102, v103
    s_nop 1
    v_mfma_f32_16x16x32_bf16 v[76:79], v[52:55], v[8:11], 0
    v_lshlrev_b32 v136, 16, v96
    v_and_b32 v144, 0xffff0000, v96
    v_lshlrev_b32 v137, 16, v97
    v_mfma_f32_16x16x32_bf16 v[84:87], v[52:55], v[10:13], 0
    v_and_b32 v145, 0xffff0000, v97
    v_lshlrev_b32 v138, 16, v98
    v_and_b32 v146, 0xffff0000, v98
    v_mfma_f32_16x16x32_bf16 v[80:83], v[52:55], v[20:23], 0
    v_lshlrev_b32 v139, 16, v99
    v_and_b32 v147, 0xffff0000, v99
    v_mul_f32 v100, v64, v136
    v_mfma_f32_16x16x32_bf16 v[88:91], v[52:55], v[22:25], 0
    v_mul_f32 v104, v72, v136
    v_mul_f32 v101, v65, v137
    v_mul_f32 v105, v73, v137
    v_mul_f32 v102, v66, v138
    v_mul_f32 v106, v74, v138
    v_mul_f32 v103, v67, v139
    v_mul_f32 v107, v75, v139
    v_fma_f32 v100, -v72, v144, v100
    v_fmac_f32 v104, v64, v144
    v_fma_f32 v101, -v73, v145, v101
    v_fmac_f32 v105, v65, v145
    v_fma_f32 v102, -v74, v146, v102
    v_fmac_f32 v106, v66, v146
    v_fma_f32 v103, -v75, v147, v103
    v_fmac_f32 v107, v67, v147
    v_cvt_pk_bf16_f32 v56, v104, v105
    v_cvt_pk_bf16_f32 v57, v106, v107
    v_cvt_pk_bf16_f32 v58, v100, v101
    v_cvt_pk_bf16_f32 v59, v102, v103
    s_nop 1
    v_mfma_f32_16x16x32_bf16 v[76:79], v[56:59], v[14:17], v[76:79]
    v_mfma_f32_16x16x32_bf16 v[84:87], v[56:59], v[16:19], v[84:87]
    v_mfma_f32_16x16x32_bf16 v[80:83], v[56:59], v[26:29], v[80:83]
    v_mfma_f32_16x16x32_bf16 v[88:91], v[56:59], v[28:31], v[88:91]
    s_nop 4
    v_mul_f32 v100, v76, v148
    v_mul_f32 v104, v84, v148
    v_mul_f32 v101, v77, v149
    v_mul_f32 v105, v85, v149
    v_mul_f32 v102, v78, v150
    v_mul_f32 v106, v86, v150
    v_mul_f32 v103, v79, v151
    v_mul_f32 v107, v87, v151
    v_fma_f32 v100, -v84, v156, v100
    v_fmac_f32 v104, v76, v156
    v_fma_f32 v101, -v85, v157, v101
    v_fmac_f32 v105, v77, v157
    v_fma_f32 v102, -v86, v158, v102
    v_fmac_f32 v106, v78, v158
    v_fma_f32 v103, -v87, v159, v103
    v_fmac_f32 v107, v79, v159
    v_cvt_pk_bf16_f32 v44, v104, v105
    v_cvt_pk_bf16_f32 v45, v106, v107
    v_cvt_pk_bf16_f32 v46, v100, v101
    v_cvt_pk_bf16_f32 v47, v102, v103
    ds_write_b128 v35, v[44:47] offset:34816
    v_mul_f32 v100, v80, v152
    v_mul_f32 v104, v88, v152
    v_mul_f32 v101, v81, v153
    v_mul_f32 v105, v89, v153
    v_mul_f32 v102, v82, v154
    v_mul_f32 v106, v90, v154
    v_mul_f32 v103, v83, v155
    v_mul_f32 v107, v91, v155
    v_fma_f32 v100, -v88, v160, v100
    v_fmac_f32 v104, v80, v160
    v_fma_f32 v101, -v89, v161, v101
    v_fmac_f32 v105, v81, v161
    v_fma_f32 v102, -v90, v162, v102
    v_fmac_f32 v106, v82, v162
    v_fma_f32 v103, -v91, v163, v103
    v_fmac_f32 v107, v83, v163
    v_cvt_pk_bf16_f32 v48, v104, v105
    v_cvt_pk_bf16_f32 v49, v106, v107
    v_cvt_pk_bf16_f32 v50, v100, v101
    v_cvt_pk_bf16_f32 v51, v102, v103
    ds_write_b128 v35, v[48:51] offset:38912
    v_mov_b32 v24, v36
    s_waitcnt lgkmcnt(0)
    s_barrier
    ds_read_b128 v[44:47], v34 offset:34816
    ds_read_b128 v[48:51], v34 offset:35840
    ds_read_b128 v[52:55], v34 offset:36864
    ds_read_b128 v[56:59], v34 offset:37888
    ds_read_b128 v[60:63], v34 offset:38912
    ds_read_b128 v[64:67], v34 offset:39936
    ds_read_b128 v[68:71], v34 offset:40960
    ds_read_b128 v[72:75], v34 offset:41984
    s_waitcnt lgkmcnt(7)
    v_mfma_f32_16x16x32_bf16 v[76:79], v[44:47], v[108:111], 0
    v_mfma_f32_16x16x32_bf16 v[84:87], v[44:47], v[110:113], 0
    s_waitcnt lgkmcnt(6)
    v_mfma_f32_16x16x32_bf16 v[76:79], v[48:51], v[114:117], v[76:79]
    v_mfma_f32_16x16x32_bf16 v[84:87], v[48:51], v[116:119], v[84:87]
    s_waitcnt lgkmcnt(5)
    v_mfma_f32_16x16x32_bf16 v[76:79], v[52:55], v[120:123], v[76:79]
    v_mfma_f32_16x16x32_bf16 v[84:87], v[52:55], v[122:125], v[84:87]
    s_waitcnt lgkmcnt(4)
    v_mfma_f32_16x16x32_bf16 v[76:79], v[56:59], v[126:129], v[76:79]
    v_mfma_f32_16x16x32_bf16 v[84:87], v[56:59], v[128:131], v[84:87]
    s_waitcnt lgkmcnt(3)
    v_mfma_f32_16x16x32_bf16 v[80:83], v[60:63], v[108:111], 0
    v_mfma_f32_16x16x32_bf16 v[88:91], v[60:63], v[110:113], 0
    s_waitcnt lgkmcnt(2)
    v_mfma_f32_16x16x32_bf16 v[80:83], v[64:67], v[114:117], v[80:83]
    v_mfma_f32_16x16x32_bf16 v[88:91], v[64:67], v[116:119], v[88:91]
    s_waitcnt lgkmcnt(1)
    v_mfma_f32_16x16x32_bf16 v[80:83], v[68:71], v[120:123], v[80:83]
    v_mfma_f32_16x16x32_bf16 v[88:91], v[68:71], v[122:125], v[88:91]
    v_cvt_pk_bf16_f32 v92, v76, v77
    v_cvt_pk_bf16_f32 v94, v78, v79
    v_cvt_pk_bf16_f32 v93, v84, v85
    s_waitcnt lgkmcnt(0)
    v_mfma_f32_16x16x32_bf16 v[80:83], v[72:75], v[126:129], v[80:83]
    v_cvt_pk_bf16_f32 v95, v86, v87
    v_bfi_b32 v92, s61, v4, v92
    v_bfi_b32 v93, s61, v5, v93
    v_mfma_f32_16x16x32_bf16 v[88:91], v[72:75], v[128:131], v[88:91]
    v_bfi_b32 v94, s61, v6, v94
    v_bfi_b32 v95, s61, v7, v95
    buffer_store_dwordx4 v[92:95], v40, s[8:11], s30 offen sc0 sc1
    s_nop 0
    v_cvt_pk_bf16_f32 v96, v80, v81
    v_cvt_pk_bf16_f32 v98, v82, v83
    s_nop 1
    v_cvt_pk_bf16_f32 v97, v88, v89
    v_cvt_pk_bf16_f32 v99, v90, v91
    v_bfi_b32 v96, s61, v4, v96
    v_bfi_b32 v97, s61, v5, v97
    v_bfi_b32 v98, s61, v6, v98
    v_bfi_b32 v99, s61, v7, v99
    buffer_store_dwordx4 v[96:99], v40, s[8:11], s33 offen sc0 sc1
    s_cmp_eq_u32 s74, 256
    s_cbranch_scc1 L_end
    s_setprio 1
    global_load_dword v20, v24, s[64:65] offset:0
    global_load_dword v16, v24, s[68:69] offset:0
    global_load_dword v21, v24, s[64:65] offset:64
    global_load_dword v17, v24, s[68:69] offset:64
    global_load_dword v22, v24, s[64:65] offset:128
    global_load_dword v18, v24, s[68:69] offset:128
    global_load_dword v23, v24, s[64:65] offset:192
    global_load_dword v19, v24, s[68:69] offset:192
    s_mul_i32 s32, s32, 1088
    v_add_u32 v32, s32, v24
    v_add_u32 v33, 8704, v32
    ds_read2_b32 v[8:9], v32 offset0:0 offset1:16
    ds_read2_b32 v[10:11], v32 offset0:32 offset1:48
    ds_read2_b32 v[12:13], v33 offset0:0 offset1:16
    ds_read2_b32 v[14:15], v33 offset0:32 offset1:48
    v_lshlrev_b32 v33, 3, v24
    s_lshl_b32 s26, s21, 12
    s_mul_i32 s27, s23, 16512
    s_add_u32 s27, s27, 0x6c0000
    s_add_u32 s28, s27, 16384
    s_add_u32 s27, s27, s26
    s_mul_i32 s29, s23, 17280
    s_add_u32 s29, s29, s26
    s_add_u32 s29, s29, 0x900000
    v_cvt_f32_u32 v35, v2
    v_lshlrev_b32 v36, 2, v3
    v_cvt_f32_u32 v36, v36
    v_mul_f32 v35, 0x3d800000, v35
    v_mul_f32 v37, v35, v36
    v_mov_b32 v38, v37
    v_add_f32 v39, v35, v37
    v_fmamk_f32 v40, v35, 0x40000000, v37
    v_fmamk_f32 v41, v35, 0x40400000, v37
    v_mul_f32 v72, 0x3d800000, v38
    v_mul_f32 v73, 0x3d800000, v39
    v_mul_f32 v74, 0x3d800000, v40
    v_mul_f32 v75, 0x3d800000, v41
    v_cos_f32 v42, v38
    v_cos_f32 v43, v39
    v_cos_f32 v44, v40
    v_cos_f32 v45, v41
    v_sin_f32 v38, v38
    v_sin_f32 v39, v39
    v_sin_f32 v40, v40
    v_sin_f32 v41, v41
    v_cvt_pk_bf16_f32 v48, v42, v43
    v_cvt_pk_bf16_f32 v49, v44, v45
    v_cvt_pk_bf16_f32 v46, -v38, -v39
    v_cvt_pk_bf16_f32 v47, -v40, -v41
    v_cvt_pk_bf16_f32 v50, v38, v39
    v_cvt_pk_bf16_f32 v51, v40, v41
    v_cos_f32 v64, v72
    v_cos_f32 v65, v73
    v_cos_f32 v66, v74
    v_cos_f32 v67, v75
    v_sin_f32 v72, v72
    v_sin_f32 v73, v73
    v_sin_f32 v74, v74
    v_sin_f32 v75, v75
    v_add_f32 v35, 0x3d000000, v35
    v_mul_f32 v37, v35, v36
    v_mov_b32 v80, v37
    v_add_f32 v81, v35, v37
    v_fmamk_f32 v82, v35, 0x40000000, v37
    v_fmamk_f32 v83, v35, 0x40400000, v37
    v_mul_f32 v76, 0x3d800000, v80
    v_mul_f32 v77, 0x3d800000, v81
    v_mul_f32 v78, 0x3d800000, v82
    v_mul_f32 v79, 0x3d800000, v83
    v_cos_f32 v84, v80
    v_cos_f32 v85, v81
    v_cos_f32 v86, v82
    v_cos_f32 v87, v83
    v_sin_f32 v80, v80
    v_sin_f32 v81, v81
    v_sin_f32 v82, v82
    v_sin_f32 v83, v83
    v_cvt_pk_bf16_f32 v54, v84, v85
    v_cvt_pk_bf16_f32 v55, v86, v87
    v_cvt_pk_bf16_f32 v52, -v80, -v81
    v_cvt_pk_bf16_f32 v53, -v82, -v83
    v_cvt_pk_bf16_f32 v56, v80, v81
    v_cvt_pk_bf16_f32 v57, v82, v83
    v_cos_f32 v68, v76
    v_cos_f32 v69, v77
    v_cos_f32 v70, v78
    v_cos_f32 v71, v79
    v_sin_f32 v76, v76
    v_sin_f32 v77, v77
    v_sin_f32 v78, v78
    v_sin_f32 v79, v79
    v_and_b32 v124, 48, v34
    v_xor_b32 v58, 0x80008000, v52
    v_xor_b32 v59, 0x80008000, v53
    v_xor_b32 v60, 0x80008000, v54
    v_xor_b32 v61, 0x80008000, v55
    v_xor_b32 v62, 0x80008000, v56
    v_xor_b32 v63, 0x80008000, v57
    s_lshr_b32 s38, s21, 1
    s_lshl_b32 s38, s38, 3
    v_add_u32 v125, s38, v33
    s_add_u32 s39, s38, 6672
    v_sub_u32 v126, s39, v33
    v_add_u32 v127, 1536, v126
    v_and_b32 v127, 8191, v127
    s_lshl_b32 s40, s21, 3
    v_add_u32 v128, s40, v33
    v_lshrrev_b32 v32, 2, v1
    v_lshlrev_b32 v129, 5, v32
    v_and_b32 v32, 1, v1
    v_lshl_add_u32 v129, v32, 4, v129
    s_lshl_b32 s35, s21, 11
    v_add_u32 v129, s35, v129
    s_mov_b32 s37, 0x07060302
    s_bitcmp1_b32 s21, 0
    s_cselect_b32 s43, s37, 0x05040100
    s_lshl_b32 s36, s24, 1
    s_lshl_b32 s50, 0x33333333, s36
    s_mov_b32 s51, s50
    s_cmp_eq_u32 s21, 0
    s_cselect_b32 s48, 0xfffffff5, -1
    s_mov_b32 s49, -1
    s_waitcnt vmcnt(0) lgkmcnt(0)
    s_mov_b32 s16, s66
    s_mov_b32 s17, s67
    s_mov_b32 s18, 0x200000
    s_mov_b32 s19, 0x20000
    v_dot2_f32_bf16 v148, v8, v20, 0
    v_dot2_f32_bf16 v149, v12, v20, 0
    v_dot2_f32_bf16 v148, v9, v21, v148
    v_dot2_f32_bf16 v149, v13, v21, v149
    v_dot2_f32_bf16 v148, v10, v22, v148
    v_dot2_f32_bf16 v149, v14, v22, v149
    v_dot2_f32_bf16 v148, v11, v23, v148
    v_dot2_f32_bf16 v149, v15, v23, v149
    v_lshlrev_b32 v80, 16, v16
    v_and_b32 v84, 0xffff0000, v16
    v_lshlrev_b32 v81, 16, v17
    v_add_f32_dpp v148, v148, v148 quad_perm:[1,0,3,2] row_mask:0xf bank_mask:0xf
    v_add_f32_dpp v149, v149, v149 quad_perm:[1,0,3,2] row_mask:0xf bank_mask:0xf
    s_mov_b32 vcc_lo, 0xaaaaaaaa
    s_mov_b32 vcc_hi, 0xaaaaaaaa
    v_cndmask_b32 v148, v148, v149, vcc
    v_and_b32 v85, 0xffff0000, v17
    v_lshlrev_b32 v82, 16, v18
    v_add_f32_dpp v148, v148, v148 quad_perm:[2,3,0,1] row_mask:0xf bank_mask:0xf
    v_and_b32 v86, 0xffff0000, v18
    v_lshlrev_b32 v83, 16, v19
    v_add_f32_dpp v148, v148, v148 row_ror:4 row_mask:0xf bank_mask:0xf
    v_and_b32 v87, 0xffff0000, v19
    v_lshlrev_b32 v132, 16, v8
    v_add_f32_dpp v148, v148, v148 row_ror:8 row_mask:0xf bank_mask:0xf
    v_mov_b32 v149, v148
    v_and_b32 v136, 0xffff0000, v8
    v_lshlrev_b32 v133, 16, v9
    v_permlane16_swap_b32 v148, v149
    v_add_f32 v148, v148, v149
    v_mov_b32 v149, v148
    v_and_b32 v137, 0xffff0000, v9
    v_lshlrev_b32 v134, 16, v10
    v_permlane32_swap_b32 v148, v149
    v_add_f32 v148, v148, v149
    v_cvt_pk_bf16_f32 v148, v148, v148
    v_lshlrev_b32 v148, 16, v148
    v_mul_f32 v148, 0xbfb8aa3b, v148
    v_exp_f32 v148, v148
    v_and_b32 v138, 0xffff0000, v10
    v_add_f32 v148, 1.0, v148
    v_rcp_f32 v148, v148
    v_lshlrev_b32 v135, 16, v11
    v_cvt_pk_bf16_f32 v148, v148, v148
    v_lshlrev_b32 v148, 16, v148
    v_sub_f32 v149, 1.0, v148
    v_cvt_pk_bf16_f32 v149, v149, v149
    v_lshlrev_b32 v149, 16, v149
    v_mul_f32 v149, 0x358115c3, v149
    v_mul_f32 v32, 0x3f80b8ea, v148
    v_readlane_b32 s70, v148, 0
    v_readlane_b32 s71, v148, 1
    v_readlane_b32 s72, v149, 0
    v_readlane_b32 s73, v149, 1
    v_readlane_b32 s54, v32, 0
    v_readlane_b32 s55, v32, 1
    v_and_b32 v139, 0xffff0000, v11
    v_mul_f32 v132, v132, v80
    v_mul_f32 v136, v136, v84
    v_mul_f32 v133, v133, v81
    v_mul_f32 v137, v137, v85
    v_mul_f32 v134, v134, v82
    v_mul_f32 v138, v138, v86
    v_mul_f32 v135, v135, v83
    v_mul_f32 v139, v139, v87
    v_lshlrev_b32 v140, 16, v12
    v_and_b32 v144, 0xffff0000, v12
    v_lshlrev_b32 v141, 16, v13
    v_and_b32 v145, 0xffff0000, v13
    v_lshlrev_b32 v142, 16, v14
    v_and_b32 v146, 0xffff0000, v14
    v_lshlrev_b32 v143, 16, v15
    v_and_b32 v147, 0xffff0000, v15
    v_mul_f32 v140, v140, v80
    v_mul_f32 v144, v144, v84
    v_mul_f32 v141, v141, v81
    v_mul_f32 v145, v145, v85
    v_mul_f32 v142, v142, v82
    v_mul_f32 v146, v146, v86
    v_mul_f32 v143, v143, v83
    v_mul_f32 v147, v147, v87
    v_mul_f32 v132, s70, v132
    v_mul_f32 v133, s70, v133
    v_mul_f32 v134, s70, v134
    v_mul_f32 v135, s70, v135
    v_mul_f32 v136, s70, v136
    v_mul_f32 v137, s70, v137
    v_mul_f32 v138, s70, v138
    v_mul_f32 v139, s70, v139
    v_mul_f32 v140, s71, v140
    v_mul_f32 v141, s71, v141
    v_mul_f32 v142, s71, v142
    v_mul_f32 v143, s71, v143
    v_mul_f32 v144, s71, v144
    v_mul_f32 v145, s71, v145
    v_mul_f32 v146, s71, v146
    v_mul_f32 v147, s71, v147
    v_mul_f32 v80, s72, v38
    v_mul_f32 v84, s72, v42
    v_mul_f32 v38, s73, v38
    v_mul_f32 v42, s73, v42
    v_mul_f32 v81, s72, v39
    v_mul_f32 v85, s72, v43
    v_mul_f32 v39, s73, v39
    v_mul_f32 v43, s73, v43
    v_mul_f32 v82, s72, v40
    v_mul_f32 v86, s72, v44
    v_mul_f32 v40, s73, v40
    v_mul_f32 v44, s73, v44
    v_mul_f32 v83, s72, v41
    v_mul_f32 v87, s72, v45
    v_mul_f32 v41, s73, v41
    v_mul_f32 v45, s73, v45
    v_cvt_pk_bf16_f32 v16, -v80, -v81
    v_cvt_pk_bf16_f32 v17, -v82, -v83
    v_cvt_pk_bf16_f32 v18, v84, v85
    v_cvt_pk_bf16_f32 v19, v86, v87
    v_cvt_pk_bf16_f32 v20, v42, v43
    v_cvt_pk_bf16_f32 v21, v44, v45
    v_cvt_pk_bf16_f32 v22, v38, v39
    v_cvt_pk_bf16_f32 v23, v40, v41
    buffer_load_dwordx4 v[88:91], v34, s[8:11], s27 offen offset:0 sc0 sc1
    buffer_load_dwordx4 v[92:95], v34, s[8:11], s27 offen offset:1024 sc0 sc1
    buffer_load_dwordx4 v[96:99], v34, s[8:11], s27 offen offset:2048 sc0 sc1
    buffer_load_dwordx4 v[100:103], v34, s[8:11], s27 offen offset:3072 sc0 sc1
    s_setprio 0
    s_mov_b32 s62, 0
    s_waitcnt vmcnt(0)
    v_xor_b32 v88, v4, v88
    v_xor_b32 v89, v5, v89
    v_xor_b32 v90, v6, v90
    v_xor_b32 v91, v7, v91
    v_xor_b32 v92, v4, v92
    v_xor_b32 v93, v5, v93
    v_xor_b32 v94, v6, v94
    v_xor_b32 v95, v7, v95
    v_xor_b32 v96, v4, v96
    v_xor_b32 v97, v5, v97
    v_xor_b32 v98, v6, v98
    v_xor_b32 v99, v7, v99
    v_xor_b32 v100, v4, v100
    v_xor_b32 v101, v5, v101
    v_xor_b32 v102, v6, v102
    v_xor_b32 v103, v7, v103
    v_or3_b32 v32, v88, v89, v90
    v_or3_b32 v32, v32, v91, v92
    v_or3_b32 v32, v32, v93, v94
    v_or3_b32 v32, v32, v95, v96
    v_or3_b32 v32, v32, v97, v98
    v_or3_b32 v32, v32, v99, v100
    v_or3_b32 v32, v32, v101, v102
    v_or_b32 v32, v32, v103
    v_and_b32 v32, s61, v32
    v_cmp_ne_u32 vcc, 0, v32
    s_nop 0
    s_cbranch_vccnz LP3
LP3_ok:
    v_cndmask_b32 v88, 0, v88, s[48:49]
    v_cndmask_b32 v89, 0, v89, s[48:49]
    v_cndmask_b32 v90, 0, v90, s[48:49]
    v_cndmask_b32 v91, 0, v91, s[48:49]
    s_mov_b64 exec, s[50:51]
    ds_write_b128 v129, v[88:91] offset:26624
    ds_write_b128 v129, v[92:95] offset:27136
    ds_write_b128 v129, v[96:99] offset:27648
    ds_write_b128 v129, v[100:103] offset:28160
    s_mov_b64 exec, -1
    buffer_load_dwordx4 v[120:123], v124, s[8:11], s28 offen sc0 sc1
    buffer_load_dwordx4 v[104:107], v34, s[8:11], s29 offen offset:0 sc0 sc1
    buffer_load_dwordx4 v[108:111], v34, s[8:11], s29 offen offset:1024 sc0 sc1
    buffer_load_dwordx4 v[112:115], v34, s[8:11], s29 offen offset:2048 sc0 sc1
    buffer_load_dwordx4 v[116:119], v34, s[8:11], s29 offen offset:3072 sc0 sc1
    s_waitcnt lgkmcnt(0)
    s_barrier
    ds_read_b64 v[88:89], v125 offset:26624
    ds_read_b64 v[90:91], v125 offset:27136
    ds_read_b64 v[92:93], v125 offset:27648
    ds_read_b64 v[94:95], v125 offset:28160
    ds_read_b64 v[96:97], v127 offset:26624
    ds_read_b64 v[98:99], v126 offset:27648
    ds_read_b64 v[100:101], v126 offset:27136
    ds_read_b64 v[102:103], v126 offset:26624
    s_waitcnt lgkmcnt(4)
    v_perm_b32 v8, v91, v89, s43
    v_perm_b32 v9, v95, v93, s43
    v_perm_b32 v10, v90, v88, s43
    v_perm_b32 v11, v94, v92, s43
    s_waitcnt lgkmcnt(0)
    v_perm_b32 v12, v98, v96, s43
    v_perm_b32 v13, v102, v100, s43
    v_perm_b32 v14, v99, v97, s43
    v_perm_b32 v15, v103, v101, s43
    v_mfma_f32_16x16x32_bf16 v[88:91], v[8:11], v[46:49], 0
    v_mfma_f32_16x16x32_bf16 v[96:99], v[8:11], v[48:51], 0
    v_mfma_f32_16x16x32_bf16 v[88:91], v[12:15], v[46:49], v[88:91]
    v_mfma_f32_16x16x32_bf16 v[96:99], v[12:15], v[48:51], v[96:99]
    v_mfma_f32_16x16x32_bf16 v[92:95], v[8:11], v[52:55], 0
    v_mfma_f32_16x16x32_bf16 v[100:103], v[8:11], v[54:57], 0
    v_mfma_f32_16x16x32_bf16 v[92:95], v[12:15], v[58:61], v[92:95]
    v_mfma_f32_16x16x32_bf16 v[100:103], v[12:15], v[60:63], v[100:103]
    s_nop 2
    v_mul_f32 v80, v88, v64
    v_mul_f32 v84, v96, v64
    v_mul_f32 v81, v89, v65
    v_mul_f32 v85, v97, v65
    v_mul_f32 v82, v90, v66
    v_mul_f32 v86, v98, v66
    v_mul_f32 v83, v91, v67
    v_mul_f32 v87, v99, v67
    v_fma_f32 v80, -v96, v72, v80
    v_fmac_f32 v84, v88, v72
    v_fma_f32 v81, -v97, v73, v81
    v_fmac_f32 v85, v89, v73
    v_fma_f32 v82, -v98, v74, v82
    v_fmac_f32 v86, v90, v74
    v_fma_f32 v83, -v99, v75, v83
    v_fmac_f32 v87, v91, v75
    v_cvt_pk_bf16_f32 v8, v84, v85
    v_cvt_pk_bf16_f32 v9, v86, v87
    v_cvt_pk_bf16_f32 v10, v80, v81
    v_cvt_pk_bf16_f32 v11, v82, v83
    v_mul_f32 v80, v92, v68
    v_mul_f32 v84, v100, v68
    v_mul_f32 v81, v93, v69
    v_mul_f32 v85, v101, v69
    v_mul_f32 v82, v94, v70
    v_mul_f32 v86, v102, v70
    v_mul_f32 v83, v95, v71
    v_mul_f32 v87, v103, v71
    v_fma_f32 v80, -v100, v76, v80
    v_fmac_f32 v84, v92, v76
    v_fma_f32 v81, -v101, v77, v81
    v_fmac_f32 v85, v93, v77
    v_fma_f32 v82, -v102, v78, v82
    v_fmac_f32 v86, v94, v78
    v_fma_f32 v83, -v103, v79, v83
    v_fmac_f32 v87, v95, v79
    v_cvt_pk_bf16_f32 v12, v84, v85
    v_cvt_pk_bf16_f32 v13, v86, v87
    v_cvt_pk_bf16_f32 v14, v80, v81
    v_cvt_pk_bf16_f32 v15, v82, v83
    s_mov_b32 s62, 0
    s_waitcnt vmcnt(4)
    v_xor_b32 v120, v4, v120
    v_xor_b32 v121, v5, v121
    v_xor_b32 v122, v6, v122
    v_xor_b32 v123, v7, v123
    v_or3_b32 v32, v120, v121, v122
    v_or_b32 v32, v32, v123
    v_and_b32 v32, s61, v32
    v_cmp_ne_u32 vcc, 0, v32
    s_nop 0
    s_cbranch_vccnz LP4
LP4_ok:
    s_bitcmp1_b32 s21, 1
    s_cselect_b64 vcc, -1, 0
    v_cndmask_b32 v80, v120, v122, vcc
    v_cndmask_b32 v81, v121, v123, vcc
    v_perm_b32 v80, v80, 0, s43
    v_perm_b32 v81, v81, 0, s43
    v_mul_f32 v80, s72, v80
    v_mul_f32 v81, s73, v81
    v_mfma_f32_16x16x32_bf16 v[132:135], v[16:19], v[8:11], v[132:135]
    v_mfma_f32_16x16x32_bf16 v[136:139], v[16:19], v[12:15], v[136:139]
    v_mfma_f32_16x16x32_bf16 v[140:143], v[20:23], v[8:11], v[140:143]
    v_mfma_f32_16x16x32_bf16 v[144:147], v[20:23], v[12:15], v[144:147]
    v_readlane_b32 s56, v80, s36
    v_readlane_b32 s57, v81, s36
    s_nop 2
    v_add_f32 v132, s56, v132
    v_subrev_f32 v136, s56, v136
    v_add_f32 v133, s56, v133
    v_subrev_f32 v137, s56, v137
    v_add_f32 v134, s56, v134
    v_subrev_f32 v138, s56, v138
    v_add_f32 v135, s56, v135
    v_subrev_f32 v139, s56, v139
    v_add_f32 v140, s57, v140
    v_subrev_f32 v144, s57, v144
    v_add_f32 v141, s57, v141
    v_subrev_f32 v145, s57, v145
    v_add_f32 v142, s57, v142
    v_subrev_f32 v146, s57, v146
    v_add_f32 v143, s57, v143
    v_subrev_f32 v147, s57, v147
    s_mov_b32 s62, 0
    s_waitcnt vmcnt(0)
    v_xor_b32 v104, v4, v104
    v_xor_b32 v105, v5, v105
    v_xor_b32 v106, v6, v106
    v_xor_b32 v107, v7, v107
    v_xor_b32 v108, v4, v108
    v_xor_b32 v109, v5, v109
    v_xor_b32 v110, v6, v110
    v_xor_b32 v111, v7, v111
    v_xor_b32 v112, v4, v112
    v_xor_b32 v113, v5, v113
    v_xor_b32 v114, v6, v114
    v_xor_b32 v115, v7, v115
    v_xor_b32 v116, v4, v116
    v_xor_b32 v117, v5, v117
    v_xor_b32 v118, v6, v118
    v_xor_b32 v119, v7, v119
    v_or3_b32 v32, v104, v105, v106
    v_or3_b32 v32, v32, v107, v108
    v_or3_b32 v32, v32, v109, v110
    v_or3_b32 v32, v32, v111, v112
    v_or3_b32 v32, v32, v113, v114
    v_or3_b32 v32, v32, v115, v116
    v_or3_b32 v32, v32, v117, v118
    v_or_b32 v32, v32, v119
    v_and_b32 v32, s61, v32
    v_cmp_ne_u32 vcc, 0, v32
    s_nop 0
    s_cbranch_vccnz LP5
LP5_ok:
    s_mov_b64 exec, s[50:51]
    ds_write_b128 v129, v[104:107] offset:18432
    ds_write_b128 v129, v[108:111] offset:18944
    ds_write_b128 v129, v[112:115] offset:19456
    ds_write_b128 v129, v[116:119] offset:19968
    s_mov_b64 exec, -1
    s_waitcnt lgkmcnt(0)
    s_barrier
    ds_read_b64 v[104:105], v128 offset:18432
    ds_read_b64 v[106:107], v128 offset:18944
    ds_read_b64 v[108:109], v128 offset:19456
    ds_read_b64 v[110:111], v128 offset:19968
    s_waitcnt lgkmcnt(0)
    v_lshlrev_b32 v112, 16, v104
    v_and_b32 v116, 0xffff0000, v104
    v_lshlrev_b32 v113, 16, v106
    v_and_b32 v117, 0xffff0000, v106
    v_lshlrev_b32 v114, 16, v108
    v_and_b32 v118, 0xffff0000, v108
    v_lshlrev_b32 v115, 16, v110
    v_and_b32 v119, 0xffff0000, v110
    v_fmac_f32 v132, s54, v112
    v_fmac_f32 v136, s54, v116
    v_fmac_f32 v133, s54, v113
    v_fmac_f32 v137, s54, v117
    v_fmac_f32 v134, s54, v114
    v_fmac_f32 v138, s54, v118
    v_fmac_f32 v135, s54, v115
    v_fmac_f32 v139, s54, v119
    v_cvt_pk_bf16_f32 v132, v132, v136
    v_cvt_pk_bf16_f32 v133, v133, v137
    v_cvt_pk_bf16_f32 v134, v134, v138
    v_cvt_pk_bf16_f32 v135, v135, v139
    buffer_store_dword v132, v24, s[16:19], s41 offen offset:0 sc0 sc1
    buffer_store_dword v133, v24, s[16:19], s41 offen offset:64 sc0 sc1
    buffer_store_dword v134, v24, s[16:19], s41 offen offset:128 sc0 sc1
    buffer_store_dword v135, v24, s[16:19], s41 offen offset:192 sc0 sc1
    v_lshlrev_b32 v112, 16, v105
    v_and_b32 v116, 0xffff0000, v105
    v_lshlrev_b32 v113, 16, v107
    v_and_b32 v117, 0xffff0000, v107
    v_lshlrev_b32 v114, 16, v109
    v_and_b32 v118, 0xffff0000, v109
    v_lshlrev_b32 v115, 16, v111
    v_and_b32 v119, 0xffff0000, v111
    v_fmac_f32 v140, s55, v112
    v_fmac_f32 v144, s55, v116
    v_fmac_f32 v141, s55, v113
    v_fmac_f32 v145, s55, v117
    v_fmac_f32 v142, s55, v114
    v_fmac_f32 v146, s55, v118
    v_fmac_f32 v143, s55, v115
    v_fmac_f32 v147, s55, v119
    v_cvt_pk_bf16_f32 v140, v140, v144
    v_cvt_pk_bf16_f32 v141, v141, v145
    v_cvt_pk_bf16_f32 v142, v142, v146
    v_cvt_pk_bf16_f32 v143, v143, v147
    buffer_store_dword v140, v24, s[16:19], s42 offen offset:0 sc0 sc1
    buffer_store_dword v141, v24, s[16:19], s42 offen offset:64 sc0 sc1
    buffer_store_dword v142, v24, s[16:19], s42 offen offset:128 sc0 sc1
    buffer_store_dword v143, v24, s[16:19], s42 offen offset:192 sc0 sc1
    s_or_b32 s36, s74, s21
    s_cmp_lg_u32 s36, 0
    s_cbranch_scc1 L_end
    v_mov_b32 v32, s60
    s_mov_b32 s36, 0xb40000
    s_mov_b64 exec, 1
    buffer_store_dword v32, v34, s[8:11], s36 offen sc0 sc1
L_end:
    s_endpgm
LP2:
LP2_e:
    s_wqm_b64 exec, vcc
    buffer_load_dwordx4 v[92:95], v34, s[8:11], s26 offen offset:0 sc0 sc1
    buffer_load_dwordx4 v[96:99], v34, s[8:11], s26 offen offset:1024 sc0 sc1
LP2_w:
    s_waitcnt vmcnt(0)
    v_xor_b32 v92, v4, v92
    v_xor_b32 v93, v5, v93
    v_xor_b32 v94, v6, v94
    v_xor_b32 v95, v7, v95
    v_xor_b32 v96, v4, v96
    v_xor_b32 v97, v5, v97
    v_xor_b32 v98, v6, v98
    v_xor_b32 v99, v7, v99
    v_or3_b32 v32, v92, v93, v94
    v_or3_b32 v32, v32, v95, v96
    v_or3_b32 v32, v32, v97, v98
    v_or_b32 v32, v32, v99
    v_and_b32 v32, s61, v32
    v_cmp_ne_u32 vcc, 0, v32
    s_add_u32 s62, s62, 1
    s_cmp_lt_u32 s62, 65536
    s_cselect_b64 vcc, vcc, 0
    s_cbranch_vccnz LP2
    s_mov_b64 exec, -1
    s_branch LP2_ok
LP3:
LP3_e:
    s_wqm_b64 exec, vcc
    buffer_load_dwordx4 v[88:91], v34, s[8:11], s27 offen offset:0 sc0 sc1
    buffer_load_dwordx4 v[92:95], v34, s[8:11], s27 offen offset:1024 sc0 sc1
    buffer_load_dwordx4 v[96:99], v34, s[8:11], s27 offen offset:2048 sc0 sc1
    buffer_load_dwordx4 v[100:103], v34, s[8:11], s27 offen offset:3072 sc0 sc1
LP3_w:
    s_waitcnt vmcnt(0)
    v_xor_b32 v88, v4, v88
    v_xor_b32 v89, v5, v89
    v_xor_b32 v90, v6, v90
    v_xor_b32 v91, v7, v91
    v_xor_b32 v92, v4, v92
    v_xor_b32 v93, v5, v93
    v_xor_b32 v94, v6, v94
    v_xor_b32 v95, v7, v95
    v_xor_b32 v96, v4, v96
    v_xor_b32 v97, v5, v97
    v_xor_b32 v98, v6, v98
    v_xor_b32 v99, v7, v99
    v_xor_b32 v100, v4, v100
    v_xor_b32 v101, v5, v101
    v_xor_b32 v102, v6, v102
    v_xor_b32 v103, v7, v103
    v_or3_b32 v32, v88, v89, v90
    v_or3_b32 v32, v32, v91, v92
    v_or3_b32 v32, v32, v93, v94
    v_or3_b32 v32, v32, v95, v96
    v_or3_b32 v32, v32, v97, v98
    v_or3_b32 v32, v32, v99, v100
    v_or3_b32 v32, v32, v101, v102
    v_or_b32 v32, v32, v103
    v_and_b32 v32, s61, v32
    v_cmp_ne_u32 vcc, 0, v32
    s_add_u32 s62, s62, 1
    s_cmp_lt_u32 s62, 65536
    s_cselect_b64 vcc, vcc, 0
    s_cbranch_vccnz LP3
    s_mov_b64 exec, -1
    s_branch LP3_ok
LP4:
LP4_e:
    s_wqm_b64 exec, vcc
    buffer_load_dwordx4 v[120:123], v124, s[8:11], s28 offen sc0 sc1
LP4_w:
    s_waitcnt vmcnt(0)
    v_xor_b32 v120, v4, v120
    v_xor_b32 v121, v5, v121
    v_xor_b32 v122, v6, v122
    v_xor_b32 v123, v7, v123
    v_or3_b32 v32, v120, v121, v122
    v_or_b32 v32, v32, v123
    v_and_b32 v32, s61, v32
    v_cmp_ne_u32 vcc, 0, v32
    s_add_u32 s62, s62, 1
    s_cmp_lt_u32 s62, 65536
    s_cselect_b64 vcc, vcc, 0
    s_cbranch_vccnz LP4
    s_mov_b64 exec, -1
    s_branch LP4_ok
LP5:
LP5_e:
    s_wqm_b64 exec, vcc
    buffer_load_dwordx4 v[104:107], v34, s[8:11], s29 offen offset:0 sc0 sc1
    buffer_load_dwordx4 v[108:111], v34, s[8:11], s29 offen offset:1024 sc0 sc1
    buffer_load_dwordx4 v[112:115], v34, s[8:11], s29 offen offset:2048 sc0 sc1
    buffer_load_dwordx4 v[116:119], v34, s[8:11], s29 offen offset:3072 sc0 sc1
LP5_w:
    s_waitcnt vmcnt(0)
    v_xor_b32 v104, v4, v104
    v_xor_b32 v105, v5, v105
    v_xor_b32 v106, v6, v106
    v_xor_b32 v107, v7, v107
    v_xor_b32 v108, v4, v108
    v_xor_b32 v109, v5, v109
    v_xor_b32 v110, v6, v110
    v_xor_b32 v111, v7, v111
    v_xor_b32 v112, v4, v112
    v_xor_b32 v113, v5, v113
    v_xor_b32 v114, v6, v114
    v_xor_b32 v115, v7, v115
    v_xor_b32 v116, v4, v116
    v_xor_b32 v117, v5, v117
    v_xor_b32 v118, v6, v118
    v_xor_b32 v119, v7, v119
    v_or3_b32 v32, v104, v105, v106
    v_or3_b32 v32, v32, v107, v108
    v_or3_b32 v32, v32, v109, v110
    v_or3_b32 v32, v32, v111, v112
    v_or3_b32 v32, v32, v113, v114
    v_or3_b32 v32, v32, v115, v116
    v_or3_b32 v32, v32, v117, v118
    v_or_b32 v32, v32, v119
    v_and_b32 v32, s61, v32
    v_cmp_ne_u32 vcc, 0, v32
    s_add_u32 s62, s62, 1
    s_cmp_lt_u32 s62, 65536
    s_cselect_b64 vcc, vcc, 0
    s_cbranch_vccnz LP5
    s_mov_b64 exec, -1
    s_branch LP5_ok
L_only2:
    s_cmp_ge_u32 s2, 513
    s_cbranch_scc1 L_exit
    s_movk_i32 s74, 256
    v_mov_b32 v80, 0
    s_mov_b32 s20, 0
    s_mov_b32 s23, 0
    v_and_b32 v1, 63, v0
    v_lshrrev_b32 v2, 6, v0
    v_and_b32 v3, 48, v0
    v_readfirstlane_b32 s21, v2
    v_and_b32 v2, 15, v0
    v_lshrrev_b32 v3, 4, v3
    s_waitcnt lgkmcnt(0)
    s_load_dword s60, s[4:5], s34
    s_mov_b32 s8, s4
    s_mov_b32 s9, s5
    s_mov_b32 s10, 0xb80000
    s_mov_b32 s11, 0x20000
    s_waitcnt lgkmcnt(0)
    s_add_u32 s60, s60, 0x10000
    s_and_b32 s60, s60, 0xfffffee8
    s_or_b32 s60, s60, 1
    s_mov_b32 s61, 0x00010001
    v_lshlrev_b32 v7, 2, v0
    v_and_b32 v7, 12, v7
    v_lshrrev_b32 v7, v7, s60
    v_and_b32 v4, s61, v7
    v_lshrrev_b32 v5, 1, v7
    v_and_b32 v5, s61, v5
    v_lshrrev_b32 v6, 2, v7
    v_and_b32 v6, s61, v6
    v_lshrrev_b32 v7, 3, v7
    v_and_b32 v7, s61, v7
    s_setprio 0
    s_branch L_consts
L_roleA:
    s_setprio 1
    v_and_b32 v1, 63, v0
    v_lshrrev_b32 v2, 6, v0
    v_and_b32 v3, 48, v0
    v_readfirstlane_b32 s21, v2
    v_and_b32 v2, 15, v0
    v_lshrrev_b32 v3, 4, v3
    s_lshr_b32 s38, s21, 1
    s_and_b32 s39, s21, 1
    s_mul_i32 s56, s21, 10112
    s_mov_b32 m0, s56
    v_mul_u32_u24 v138, 272, v2
    v_lshl_add_u32 v138, v3, 4, v138
    v_add_u32 v138, s56, v138
    s_mul_i32 s55, s38, 4640
    s_add_u32 s55, s55, 44048
    s_lshl_b32 s54, s39, 8
    s_cmp_eq_u32 s39, 0
    s_cselect_b64 s[70:71], -1, 0
    v_lshlrev_b32 v147, 4, v0
    v_lshlrev_b32 v137, 4, v1
    s_xor_b32 s57, s21, 1
    s_mul_i32 s57, s57, 10112
    v_add_u32 v149, s56, v137
    v_add_u32 v150, s57, v137
    s_add_u32 s57, s54, s55
    v_lshl_add_u32 v140, v3, 6, s57
    v_lshlrev_b32 v136, 1, v2
    v_add_u32 v136, 240, v136
    v_cmp_gt_u32 vcc, 8, v2
    v_and_b32 v137, 2, v2
    v_lshlrev_b32 v137, 7, v137
    v_cndmask_b32 v139, v136, v2, vcc
    v_and_b32 v136, 1, v2
    v_cmp_gt_u32 vcc, 12, v2
    v_lshl_add_u32 v136, v136, 2, v137
    v_add_u32 v136, 512, v136
    v_cndmask_b32 v139, v136, v139, vcc
    v_lshl_add_u32 v139, v139, 1, v140
    v_lshl_add_u32 v140, v2, 9, v140
    s_mov_b32 s8, s4
    s_mov_b32 s9, s5
    s_mov_b32 s10, 0xb80000
    s_mov_b32 s11, 0x20000
    v_mov_b32 v137, 0
    s_sub_u32 s57, s55, 4
    v_mov_b32 v136, s57
    s_waitcnt lgkmcnt(0)
    ds_write_b32 v136, v137
    s_lshl_b32 s37, s38, 4
    s_lshr_b32 s36, s36, s37
    s_lshl_b32 s36, s36, 16
    v_mov_b32 v16, 0x3fb8aa3b
    v_mul_f32 v16, s36, v16
    v_exp_f32 v16, v16
    s_add_u32 s60, s60, 0x10000
    s_and_b32 s60, s60, 0xfffffee8
    s_or_b32 s60, s60, 1
    s_mov_b32 s61, 0x00010001
    v_lshlrev_b32 v7, 2, v0
    v_and_b32 v7, 12, v7
    v_lshrrev_b32 v7, v7, s60
    v_and_b32 v4, s61, v7
    v_lshrrev_b32 v5, 1, v7
    v_and_b32 v5, s61, v5
    v_lshrrev_b32 v6, 2, v7
    v_and_b32 v6, s61, v6
    v_lshrrev_b32 v7, 3, v7
    v_and_b32 v7, s61, v7
    v_cvt_pk_bf16_f32 v16, v16, v16
    v_lshlrev_b32 v16, 16, v16
    v_mov_b32 v137, 0x3f80
    ds_write_addtid_b32 v137 offset:5712
    s_waitcnt vmcnt(5)
    v_mul_f32 v8, 0x3fb8aa3b, v8
    v_exp_f32 v8, v8
    s_waitcnt vmcnt(4)
    v_mul_f32 v9, v9, v16
    v_cvt_pk_bf16_f32 v8, v8, v8
    v_mul_f32 v9, 0.15915494, v9
    v_lshlrev_b32 v8, 16, v8
    v_mul_f32 v8, v8, v16
    v_mul_f32 v8, 0xbfb8aa3b, v8
    v_mul_f32 v12, 0x41000000, v8
    v_mul_f32 v13, 0x41000000, v9
    v_mul_f32 v14, 0x43800000, v8
    v_mul_f32 v15, 0x43800000, v9
    v_fract_f32 v13, v13
    v_exp_f32 v12, v12
    v_cos_f32 v88, v13
    v_sin_f32 v89, v13
    v_fract_f32 v9, v9
    v_exp_f32 v8, v8
    v_cos_f32 v90, v9
    v_sin_f32 v91, v9
    v_fract_f32 v15, v15
    v_exp_f32 v14, v14
    v_cos_f32 v92, v15
    v_sin_f32 v93, v15
    v_mul_f32 v88, v88, v12
    v_mul_f32 v89, v89, v12
    v_mul_f32 v90, v90, v8
    v_mul_f32 v91, v91, v8
    v_mul_f32 v92, v92, v14
    v_mul_f32 v93, v93, v14
    v_cvt_pk_bf16_f32 v128, v88, v89
    s_waitcnt vmcnt(2)
    v_add_f32 v16, v16, v16
    v_mul_f32 v24, v10, v16
    v_mul_f32 v25, v11, v16
    v_cvt_pk_bf16_f32 v129, v24, -v25
    v_pk_mul_f32 v[112:113], v[88:89], v[88:89] op_sel_hi:[1,0]
    v_pk_mul_f32 v[114:115], v[90:91], v[90:91] op_sel_hi:[1,0]
    v_pk_mul_f32 v[116:117], v[24:25], v[90:91] op_sel_hi:[1,0]
    v_pk_fma_f32 v[76:77], v[88:89], v[88:89], v[112:113] op_sel:[1,1,0] op_sel_hi:[0,1,1] neg_lo:[1,0,0]
    v_pk_fma_f32 v[94:95], v[90:91], v[90:91], v[114:115] op_sel:[1,1,0] op_sel_hi:[0,1,1] neg_lo:[1,0,0]
    v_pk_fma_f32 v[26:27], v[24:25], v[90:91], v[116:117] op_sel:[1,1,0] op_sel_hi:[0,1,1] neg_lo:[1,0,0]
    v_cvt_pk_bf16_f32 v130, v76, v77
    v_cvt_pk_bf16_f32 v131, v26, -v27
    v_pk_mul_f32 v[112:113], v[76:77], v[88:89] op_sel_hi:[1,0]
    v_pk_mul_f32 v[114:115], v[76:77], v[76:77] op_sel_hi:[1,0]
    v_pk_mul_f32 v[116:117], v[94:95], v[94:95] op_sel_hi:[1,0]
    v_pk_mul_f32 v[118:119], v[24:25], v[94:95] op_sel_hi:[1,0]
    v_pk_mul_f32 v[120:121], v[26:27], v[94:95] op_sel_hi:[1,0]
    v_pk_mul_f32 v[122:123], v[92:93], v[92:93] op_sel_hi:[1,0]
    v_pk_fma_f32 v[78:79], v[76:77], v[88:89], v[112:113] op_sel:[1,1,0] op_sel_hi:[0,1,1] neg_lo:[1,0,0]
    v_pk_fma_f32 v[80:81], v[76:77], v[76:77], v[114:115] op_sel:[1,1,0] op_sel_hi:[0,1,1] neg_lo:[1,0,0]
    v_pk_fma_f32 v[96:97], v[94:95], v[94:95], v[116:117] op_sel:[1,1,0] op_sel_hi:[0,1,1] neg_lo:[1,0,0]
    v_pk_fma_f32 v[28:29], v[24:25], v[94:95], v[118:119] op_sel:[1,1,0] op_sel_hi:[0,1,1] neg_lo:[1,0,0]
    v_pk_fma_f32 v[30:31], v[26:27], v[94:95], v[120:121] op_sel:[1,1,0] op_sel_hi:[0,1,1] neg_lo:[1,0,0]
    v_pk_fma_f32 v[90:91], v[92:93], v[92:93], v[122:123] op_sel:[1,1,0] op_sel_hi:[0,1,1] neg_lo:[1,0,0]
    v_cvt_pk_bf16_f32 v132, v78, v79
    v_cvt_pk_bf16_f32 v133, v80, v81
    v_cvt_pk_bf16_f32 v134, v28, -v29
    v_cvt_pk_bf16_f32 v135, v30, -v31
    ds_write_addtid_b32 v128 offset:5984
    ds_write_addtid_b32 v129 offset:0
    ds_write_addtid_b32 v130 offset:6256
    ds_write_addtid_b32 v131 offset:272
    ds_write_addtid_b32 v132 offset:6528
    ds_write_addtid_b32 v133 offset:6800
    ds_write_addtid_b32 v134 offset:544
    ds_write_addtid_b32 v135 offset:816
    v_pk_mul_f32 v[112:113], v[88:89], v[80:81] op_sel_hi:[1,0]
    v_pk_mul_f32 v[114:115], v[76:77], v[80:81] op_sel_hi:[1,0]
    v_pk_mul_f32 v[116:117], v[78:79], v[80:81] op_sel_hi:[1,0]
    v_pk_mul_f32 v[118:119], v[80:81], v[80:81] op_sel_hi:[1,0]
    v_pk_mul_f32 v[120:121], v[24:25], v[96:97] op_sel_hi:[1,0]
    v_pk_mul_f32 v[122:123], v[26:27], v[96:97] op_sel_hi:[1,0]
    v_pk_mul_f32 v[124:125], v[28:29], v[96:97] op_sel_hi:[1,0]
    v_pk_mul_f32 v[126:127], v[30:31], v[96:97] op_sel_hi:[1,0]
    v_pk_fma_f32 v[82:83], v[88:89], v[80:81], v[112:113] op_sel:[1,1,0] op_sel_hi:[0,1,1] neg_lo:[1,0,0]
    v_pk_fma_f32 v[84:85], v[76:77], v[80:81], v[114:115] op_sel:[1,1,0] op_sel_hi:[0,1,1] neg_lo:[1,0,0]
    v_pk_fma_f32 v[86:87], v[78:79], v[80:81], v[116:117] op_sel:[1,1,0] op_sel_hi:[0,1,1] neg_lo:[1,0,0]
    v_pk_fma_f32 v[98:99], v[80:81], v[80:81], v[118:119] op_sel:[1,1,0] op_sel_hi:[0,1,1] neg_lo:[1,0,0]
    v_pk_fma_f32 v[32:33], v[24:25], v[96:97], v[120:121] op_sel:[1,1,0] op_sel_hi:[0,1,1] neg_lo:[1,0,0]
    v_pk_fma_f32 v[34:35], v[26:27], v[96:97], v[122:123] op_sel:[1,1,0] op_sel_hi:[0,1,1] neg_lo:[1,0,0]
    v_pk_fma_f32 v[36:37], v[28:29], v[96:97], v[124:125] op_sel:[1,1,0] op_sel_hi:[0,1,1] neg_lo:[1,0,0]
    v_pk_fma_f32 v[38:39], v[30:31], v[96:97], v[126:127] op_sel:[1,1,0] op_sel_hi:[0,1,1] neg_lo:[1,0,0]
    v_cvt_pk_bf16_f32 v128, v82, v83
    v_cvt_pk_bf16_f32 v129, v84, v85
    v_cvt_pk_bf16_f32 v130, v86, v87
    v_cvt_pk_bf16_f32 v131, v98, v99
    v_cvt_pk_bf16_f32 v132, v32, -v33
    v_cvt_pk_bf16_f32 v133, v34, -v35
    v_cvt_pk_bf16_f32 v134, v36, -v37
    v_cvt_pk_bf16_f32 v135, v38, -v39
    ds_write_addtid_b32 v128 offset:7072
    ds_write_addtid_b32 v129 offset:7344
    ds_write_addtid_b32 v130 offset:7616
    ds_write_addtid_b32 v131 offset:7888
    ds_write_addtid_b32 v132 offset:1088
    ds_write_addtid_b32 v133 offset:1360
    ds_write_addtid_b32 v134 offset:1632
    ds_write_addtid_b32 v135 offset:1904
    v_pk_mul_f32 v[112:113], v[24:25], v[92:93] op_sel_hi:[1,0]
    v_pk_mul_f32 v[114:115], v[28:29], v[92:93] op_sel_hi:[1,0]
    v_pk_mul_f32 v[116:117], v[32:33], v[92:93] op_sel_hi:[1,0]
    v_pk_mul_f32 v[118:119], v[36:37], v[92:93] op_sel_hi:[1,0]
    v_pk_mul_f32 v[120:121], v[24:25], v[90:91] op_sel_hi:[1,0]
    v_pk_mul_f32 v[122:123], v[32:33], v[90:91] op_sel_hi:[1,0]
    v_pk_mul_f32 v[124:125], v[88:89], v[98:99] op_sel_hi:[1,0]
    v_pk_mul_f32 v[126:127], v[76:77], v[98:99] op_sel_hi:[1,0]
    v_pk_fma_f32 v[26:27], v[24:25], v[92:93], v[112:113] op_sel:[1,1,0] op_sel_hi:[0,1,1] neg_lo:[1,0,0]
    v_pk_fma_f32 v[28:29], v[28:29], v[92:93], v[114:115] op_sel:[1,1,0] op_sel_hi:[0,1,1] neg_lo:[1,0,0]
    v_pk_fma_f32 v[34:35], v[32:33], v[92:93], v[116:117] op_sel:[1,1,0] op_sel_hi:[0,1,1] neg_lo:[1,0,0]
    v_pk_fma_f32 v[36:37], v[36:37], v[92:93], v[118:119] op_sel:[1,1,0] op_sel_hi:[0,1,1] neg_lo:[1,0,0]
    v_pk_fma_f32 v[24:25], v[24:25], v[90:91], v[120:121] op_sel:[1,1,0] op_sel_hi:[0,1,1] neg_lo:[1,0,0]
    v_pk_fma_f32 v[32:33], v[32:33], v[90:91], v[122:123] op_sel:[1,1,0] op_sel_hi:[0,1,1] neg_lo:[1,0,0]
    v_pk_fma_f32 v[74:75], v[88:89], v[98:99], v[124:125] op_sel:[1,1,0] op_sel_hi:[0,1,1] neg_lo:[1,0,0]
    v_pk_fma_f32 v[76:77], v[76:77], v[98:99], v[126:127] op_sel:[1,1,0] op_sel_hi:[0,1,1] neg_lo:[1,0,0]
    v_cvt_pk_bf16_f32 v128, v26, -v27
    v_cvt_pk_bf16_f32 v129, v28, -v29
    v_cvt_pk_bf16_f32 v130, v34, -v35
    v_cvt_pk_bf16_f32 v131, v36, -v37
    v_cvt_pk_bf16_f32 v132, v24, -v25
    v_cvt_pk_bf16_f32 v133, v32, -v33
    v_cvt_pk_bf16_f32 v134, v74, v75
    v_cvt_pk_bf16_f32 v135, v76, v77
    ds_write_addtid_b32 v128 offset:2176
    ds_write_addtid_b32 v129 offset:2448
    ds_write_addtid_b32 v130 offset:2720
    ds_write_addtid_b32 v131 offset:2992
    ds_write_addtid_b32 v132 offset:3264
    ds_write_addtid_b32 v133 offset:3536
    ds_write_addtid_b32 v134 offset:8160
    ds_write_addtid_b32 v135 offset:8432
    v_pk_mul_f32 v[112:113], v[26:27], v[90:91] op_sel_hi:[1,0]
    v_pk_mul_f32 v[114:115], v[34:35], v[90:91] op_sel_hi:[1,0]
    v_pk_mul_f32 v[116:117], v[24:25], v[90:91] op_sel_hi:[1,0]
    v_pk_mul_f32 v[118:119], v[78:79], v[98:99] op_sel_hi:[1,0]
    v_pk_mul_f32 v[120:121], v[80:81], v[98:99] op_sel_hi:[1,0]
    v_pk_fma_f32 v[26:27], v[26:27], v[90:91], v[112:113] op_sel:[1,1,0] op_sel_hi:[0,1,1] neg_lo:[1,0,0]
    v_pk_fma_f32 v[34:35], v[34:35], v[90:91], v[114:115] op_sel:[1,1,0] op_sel_hi:[0,1,1] neg_lo:[1,0,0]
    v_pk_fma_f32 v[24:25], v[24:25], v[90:91], v[116:117] op_sel:[1,1,0] op_sel_hi:[0,1,1] neg_lo:[1,0,0]
    v_pk_fma_f32 v[78:79], v[78:79], v[98:99], v[118:119] op_sel:[1,1,0] op_sel_hi:[0,1,1] neg_lo:[1,0,0]
    v_pk_fma_f32 v[80:81], v[80:81], v[98:99], v[120:121] op_sel:[1,1,0] op_sel_hi:[0,1,1] neg_lo:[1,0,0]
    v_cvt_pk_bf16_f32 v128, v26, -v27
    v_cvt_pk_bf16_f32 v129, v34, -v35
    v_cvt_pk_bf16_f32 v130, v24, -v25
    v_cvt_pk_bf16_f32 v131, v78, v79
    v_cvt_pk_bf16_f32 v132, v80, v81
    v_pk_mul_f32 v[112:113], v[26:27], v[90:91] op_sel_hi:[1,0]
    v_pk_mul_f32 v[114:115], v[24:25], v[90:91] op_sel_hi:[1,0]
    v_pk_mul_f32 v[116:117], v[82:83], v[98:99] op_sel_hi:[1,0]
    v_pk_mul_f32 v[118:119], v[84:85], v[98:99] op_sel_hi:[1,0]
    v_pk_fma_f32 v[26:27], v[26:27], v[90:91], v[112:113] op_sel:[1,1,0] op_sel_hi:[0,1,1] neg_lo:[1,0,0]
    v_pk_fma_f32 v[24:25], v[24:25], v[90:91], v[114:115] op_sel:[1,1,0] op_sel_hi:[0,1,1] neg_lo:[1,0,0]
    v_pk_fma_f32 v[82:83], v[82:83], v[98:99], v[116:117] op_sel:[1,1,0] op_sel_hi:[0,1,1] neg_lo:[1,0,0]
    v_pk_fma_f32 v[84:85], v[84:85], v[98:99], v[118:119] op_sel:[1,1,0] op_sel_hi:[0,1,1] neg_lo:[1,0,0]
    v_cvt_pk_bf16_f32 v133, v26, -v27
    v_cvt_pk_bf16_f32 v134, v24, -v25
    v_cvt_pk_bf16_f32 v135, v82, v83
    ds_write_addtid_b32 v128 offset:3808
    ds_write_addtid_b32 v129 offset:4080
    ds_write_addtid_b32 v130 offset:4352
    ds_write_addtid_b32 v131 offset:8704
    ds_write_addtid_b32 v132 offset:8976
    ds_write_addtid_b32 v133 offset:4624
    ds_write_addtid_b32 v134 offset:4896
    ds_write_addtid_b32 v135 offset:9248
    v_cvt_pk_bf16_f32 v128, v84, v85
    v_pk_mul_f32 v[112:113], v[26:27], v[90:91] op_sel_hi:[1,0]
    v_pk_mul_f32 v[114:115], v[24:25], v[90:91] op_sel_hi:[1,0]
    v_pk_mul_f32 v[116:117], v[86:87], v[98:99] op_sel_hi:[1,0]
    v_pk_fma_f32 v[26:27], v[26:27], v[90:91], v[112:113] op_sel:[1,1,0] op_sel_hi:[0,1,1] neg_lo:[1,0,0]
    v_pk_fma_f32 v[24:25], v[24:25], v[90:91], v[114:115] op_sel:[1,1,0] op_sel_hi:[0,1,1] neg_lo:[1,0,0]
    v_pk_fma_f32 v[86:87], v[86:87], v[98:99], v[116:117] op_sel:[1,1,0] op_sel_hi:[0,1,1] neg_lo:[1,0,0]
    v_cvt_pk_bf16_f32 v129, v26, -v27
    v_cvt_pk_bf16_f32 v130, v24, -v25
    v_cvt_pk_bf16_f32 v131, v86, v87
    ds_write_addtid_b32 v128 offset:9520
    ds_write_addtid_b32 v129 offset:5168
    ds_write_addtid_b32 v130 offset:5440
    ds_write_addtid_b32 v131 offset:9792
    ds_read_b128 v[8:11], v138 offset:5712
    ds_read_b128 v[12:15], v138 offset:5776
    ds_read_b128 v[16:19], v138 offset:5840
    ds_read_b128 v[20:23], v138 offset:5904
    ds_read_b128 v[40:43], v138 offset:0
    ds_read_b128 v[56:59], v138 offset:4352
    ds_read_b128 v[44:47], v138 offset:64
    ds_read_b128 v[60:63], v138 offset:4416
    ds_read_b128 v[48:51], v138 offset:128
    ds_read_b128 v[64:67], v138 offset:4480
    ds_read_b128 v[52:55], v138 offset:192
    ds_read_b128 v[68:71], v138 offset:4544
    v_pk_mul_f32 v[112:113], v[98:99], v[98:99] op_sel_hi:[1,0]
    v_pk_mul_f32 v[114:115], v[74:75], v[98:99] op_sel_hi:[1,0]
    v_pk_mul_f32 v[116:117], v[76:77], v[98:99] op_sel_hi:[1,0]
    v_pk_mul_f32 v[118:119], v[78:79], v[98:99] op_sel_hi:[1,0]
    v_pk_mul_f32 v[120:121], v[80:81], v[98:99] op_sel_hi:[1,0]
    v_pk_mul_f32 v[122:123], v[82:83], v[98:99] op_sel_hi:[1,0]
    v_pk_mul_f32 v[124:125], v[84:85], v[98:99] op_sel_hi:[1,0]
    v_pk_mul_f32 v[126:127], v[86:87], v[98:99] op_sel_hi:[1,0]
    v_pk_fma_f32 v[72:73], v[98:99], v[98:99], v[112:113] op_sel:[1,1,0] op_sel_hi:[0,1,1] neg_lo:[1,0,0]
    v_pk_fma_f32 v[74:75], v[74:75], v[98:99], v[114:115] op_sel:[1,1,0] op_sel_hi:[0,1,1] neg_lo:[1,0,0]
    v_pk_fma_f32 v[76:77], v[76:77], v[98:99], v[116:117] op_sel:[1,1,0] op_sel_hi:[0,1,1] neg_lo:[1,0,0]
    v_pk_fma_f32 v[78:79], v[78:79], v[98:99], v[118:119] op_sel:[1,1,0] op_sel_hi:[0,1,1] neg_lo:[1,0,0]
    v_pk_fma_f32 v[80:81], v[80:81], v[98:99], v[120:121] op_sel:[1,1,0] op_sel_hi:[0,1,1] neg_lo:[1,0,0]
    v_pk_fma_f32 v[82:83], v[82:83], v[98:99], v[122:123] op_sel:[1,1,0] op_sel_hi:[0,1,1] neg_lo:[1,0,0]
    v_pk_fma_f32 v[84:85], v[84:85], v[98:99], v[124:125] op_sel:[1,1,0] op_sel_hi:[0,1,1] neg_lo:[1,0,0]
    v_pk_fma_f32 v[86:87], v[86:87], v[98:99], v[126:127] op_sel:[1,1,0] op_sel_hi:[0,1,1] neg_lo:[1,0,0]
    v_cvt_pk_bf16_f32 v128, v72, v73
    v_cvt_pk_bf16_f32 v129, v74, v75
    v_cvt_pk_bf16_f32 v130, v76, v77
    v_cvt_pk_bf16_f32 v131, v78, v79
    v_cvt_pk_bf16_f32 v132, v80, v81
    v_cvt_pk_bf16_f32 v133, v82, v83
    v_cvt_pk_bf16_f32 v134, v84, v85
    v_cvt_pk_bf16_f32 v135, v86, v87
    ds_write_addtid_b32 v128 offset:5712
    ds_write_addtid_b32 v129 offset:5984
    ds_write_addtid_b32 v130 offset:6256
    ds_write_addtid_b32 v131 offset:6528
    ds_write_addtid_b32 v132 offset:6800
    ds_write_addtid_b32 v133 offset:7072
    ds_write_addtid_b32 v134 offset:7344
    ds_write_addtid_b32 v135 offset:7616
    v_pk_mul_f32 v[112:113], v[72:73], v[98:99] op_sel_hi:[1,0]
    v_pk_mul_f32 v[114:115], v[74:75], v[98:99] op_sel_hi:[1,0]
    v_pk_mul_f32 v[116:117], v[76:77], v[98:99] op_sel_hi:[1,0]
    v_pk_mul_f32 v[118:119], v[78:79], v[98:99] op_sel_hi:[1,0]
    v_pk_mul_f32 v[120:121], v[80:81], v[98:99] op_sel_hi:[1,0]
    v_pk_mul_f32 v[122:123], v[82:83], v[98:99] op_sel_hi:[1,0]
    v_pk_mul_f32 v[124:125], v[84:85], v[98:99] op_sel_hi:[1,0]
    v_pk_mul_f32 v[126:127], v[86:87], v[98:99] op_sel_hi:[1,0]
    v_pk_fma_f32 v[72:73], v[72:73], v[98:99], v[112:113] op_sel:[1,1,0] op_sel_hi:[0,1,1] neg_lo:[1,0,0]
    v_pk_fma_f32 v[74:75], v[74:75], v[98:99], v[114:115] op_sel:[1,1,0] op_sel_hi:[0,1,1] neg_lo:[1,0,0]
    v_pk_fma_f32 v[76:77], v[76:77], v[98:99], v[116:117] op_sel:[1,1,0] op_sel_hi:[0,1,1] neg_lo:[1,0,0]
    v_pk_fma_f32 v[78:79], v[78:79], v[98:99], v[118:119] op_sel:[1,1,0] op_sel_hi:[0,1,1] neg_lo:[1,0,0]
    v_pk_fma_f32 v[80:81], v[80:81], v[98:99], v[120:121] op_sel:[1,1,0] op_sel_hi:[0,1,1] neg_lo:[1,0,0]
    v_pk_fma_f32 v[82:83], v[82:83], v[98:99], v[122:123] op_sel:[1,1,0] op_sel_hi:[0,1,1] neg_lo:[1,0,0]
    v_pk_fma_f32 v[84:85], v[84:85], v[98:99], v[124:125] op_sel:[1,1,0] op_sel_hi:[0,1,1] neg_lo:[1,0,0]
    v_pk_fma_f32 v[86:87], v[86:87], v[98:99], v[126:127] op_sel:[1,1,0] op_sel_hi:[0,1,1] neg_lo:[1,0,0]
    v_cvt_pk_bf16_f32 v128, v72, v73
    v_cvt_pk_bf16_f32 v129, v74, v75
    v_cvt_pk_bf16_f32 v130, v76, v77
    v_cvt_pk_bf16_f32 v131, v78, v79
    v_cvt_pk_bf16_f32 v132, v80, v81
    v_cvt_pk_bf16_f32 v133, v82, v83
    v_cvt_pk_bf16_f32 v134, v84, v85
    v_cvt_pk_bf16_f32 v135, v86, v87
    ds_write_addtid_b32 v128 offset:7888
    ds_write_addtid_b32 v129 offset:8160
    ds_write_addtid_b32 v130 offset:8432
    ds_write_addtid_b32 v131 offset:8704
    ds_write_addtid_b32 v132 offset:8976
    ds_write_addtid_b32 v133 offset:9248
    ds_write_addtid_b32 v134 offset:9520
    ds_write_addtid_b32 v135 offset:9792
    ds_read_b128 v[24:27], v138 offset:5712
    ds_read_b128 v[28:31], v138 offset:5776
    ds_read_b128 v[32:35], v138 offset:5840
    ds_read_b128 v[36:39], v138 offset:5904
    s_waitcnt lgkmcnt(12)
    v_mfma_f32_16x16x32_bf16 v[72:75], v[8:11], v[40:43], 0
    v_and_b32 v136, 127, v0
    v_lshlrev_b32 v136, 4, v136
    v_mfma_f32_16x16x32_bf16 v[76:79], v[8:11], v[56:59], 0
    s_add_u32 s57, s55, 2028
    v_sub_u32 v141, s57, v136
    v_mfma_f32_16x16x32_bf16 v[72:75], v[12:15], v[44:47], v[72:75]
    s_mul_i32 s74, s38, 8320
    s_add_u32 s74, s74, 9216
    v_mfma_f32_16x16x32_bf16 v[76:79], v[12:15], v[60:63], v[76:79]
    v_add_u32 v146, s74, v136
    v_mov_b32 v137, 0x01000100
    v_mfma_f32_16x16x32_bf16 v[72:75], v[16:19], v[48:51], v[72:75]
    v_mov_b32 v136, 0x05040100
    s_mov_b32 vcc_lo, 0xaaaaaaaa
    v_mfma_f32_16x16x32_bf16 v[76:79], v[16:19], v[64:67], v[76:79]
    s_mov_b32 vcc_hi, 0xaaaaaaaa
    v_cndmask_b32 v142, v137, v136, vcc
    v_mfma_f32_16x16x32_bf16 v[72:75], v[20:23], v[52:55], v[72:75]
    s_mov_b32 s67, 0x01000504
    s_cmp_eq_u32 s39, 0
    v_mfma_f32_16x16x32_bf16 v[76:79], v[20:23], v[68:71], v[76:79]
    s_cselect_b32 s66, 0x05040504, s67
    s_cselect_b32 vcc_hi, 0, -1
    s_waitcnt lgkmcnt(3)
    v_mfma_f32_16x16x32_bf16 v[80:83], v[24:27], v[40:43], 0
    s_mov_b32 vcc_lo, 0
    s_cselect_b32 s72, 0, 0x80000000
    v_mfma_f32_16x16x32_bf16 v[84:87], v[24:27], v[56:59], 0
    s_mov_b32 s73, vcc_hi
    v_mov_b32 v136, 0x01000302
    s_waitcnt lgkmcnt(2)
    v_mfma_f32_16x16x32_bf16 v[80:83], v[28:31], v[44:47], v[80:83]
    v_cndmask_b32 v144, v137, v136, vcc
    v_mov_b32 v137, s66
    v_mfma_f32_16x16x32_bf16 v[84:87], v[28:31], v[60:63], v[84:87]
    v_cndmask_b32 v143, v137, v136, vcc
    v_mov_b32 v137, s67
    s_waitcnt lgkmcnt(1)
    v_mfma_f32_16x16x32_bf16 v[80:83], v[32:35], v[48:51], v[80:83]
    v_cndmask_b32 v145, v137, v136, vcc
    v_mfma_f32_16x16x32_bf16 v[84:87], v[32:35], v[64:67], v[84:87]
    s_waitcnt lgkmcnt(0)
    v_mfma_f32_16x16x32_bf16 v[80:83], v[36:39], v[52:55], v[80:83]
    v_mfma_f32_16x16x32_bf16 v[84:87], v[36:39], v[68:71], v[84:87]
    s_mul_i32 s22, s20, 9088
    s_add_u32 s22, s22, 0x480000
    s_add_u32 s23, s22, 4096
    v_mov_b32 v100, 0
    v_mov_b32 v101, 0
    v_mov_b32 v102, 0
    v_mov_b32 v103, 0
    v_cndmask_b32 v88, v72, v80, s[70:71]
    v_cndmask_b32 v89, v73, v81, s[70:71]
    v_cndmask_b32 v90, v74, v82, s[70:71]
    v_cndmask_b32 v91, v75, v83, s[70:71]
    v_cndmask_b32 v92, v76, v84, s[70:71]
    v_cndmask_b32 v93, v77, v85, s[70:71]
    v_cndmask_b32 v94, v78, v86, s[70:71]
    v_cndmask_b32 v95, v79, v87, s[70:71]
    ds_write_b128 v149, v[88:91] offset:0
    ds_write_b128 v149, v[92:95] offset:1024
    v_cndmask_b32 v72, v80, v72, s[70:71]
    v_cndmask_b32 v73, v81, v73, s[70:71]
    v_cndmask_b32 v74, v82, v74, s[70:71]
    v_cndmask_b32 v75, v83, v75, s[70:71]
    v_cndmask_b32 v76, v84, v76, s[70:71]
    v_cndmask_b32 v77, v85, v77, s[70:71]
    v_cndmask_b32 v78, v86, v78, s[70:71]
    v_cndmask_b32 v79, v87, v79, s[70:71]
    s_waitcnt lgkmcnt(0)
    s_barrier
    ds_read_b128 v[80:83], v150 offset:0
    ds_read_b128 v[84:87], v150 offset:1024
    v_and_b32 v137, 1, v0
    v_mul_u32_u24 v148, 4608, v137
    v_lshlrev_b32 v154, 1, v137
    v_and_b32 v136, 2, v0
    v_lshl_add_u32 v148, v136, 10, v148
    v_lshl_add_u32 v154, v136, 6, v154
    v_lshrrev_b32 v136, 2, v0
    v_lshl_add_u32 v148, v136, 4, v148
    v_mul_u32_u24 v155, 17280, v136
    v_and_b32 v136, 0x7c, v0
    v_add_u32 v154, v154, v136
    s_lshl_b32 s40, s38, 8
    v_add_lshl_u32 v154, v154, s40, 2
    v_lshrrev_b32 v136, 1, v136
    s_waitcnt lgkmcnt(0)
    v_pk_add_f32 v[72:73], v[72:73], v[80:81]
    v_pk_add_f32 v[74:75], v[74:75], v[82:83]
    v_pk_add_f32 v[76:77], v[76:77], v[84:85]
    v_pk_add_f32 v[78:79], v[78:79], v[86:87]
    v_cvt_pk_bf16_f32 v72, v72, v73
    v_cvt_pk_bf16_f32 v74, v74, v75
    v_cvt_pk_bf16_f32 v76, v76, v77
    v_cvt_pk_bf16_f32 v78, v78, v79
    ds_write_b16 v139, v72 offset:0
    ds_write_b16_d16_hi v139, v72 offset:16
    ds_write_b16 v139, v74 offset:32
    ds_write_b16_d16_hi v139, v74 offset:48
    s_mov_b32 exec_lo, 0x001f001f
    s_mov_b32 exec_hi, 0x001f001f
    ds_write_b16 v140, v76 offset:2048
    ds_write_b16_d16_hi v140, v76 offset:2064
    ds_write_b16 v140, v78 offset:2080
    ds_write_b16_d16_hi v140, v78 offset:2096
    s_mov_b64 exec, -1
    s_mov_b32 s35, 0x01000100
    v_and_b32 v136, 48, v136
    v_xor_b32 v154, v136, v154
    v_and_b32 v136, 48, v147
    v_add_u32 v155, v136, v155
    v_bfe_u32 v137, v1, 2, 1
    v_mul_u32_u24 v137, 4160, v137
    s_add_u32 s33, s74, 4096
    v_add3_u32 v136, v136, v137, s33
    s_mul_i32 s32, s38, 4608
    v_lshlrev_b32 v137, 4, v1
    v_add_u32 v152, s32, v137
    v_cndmask_b32 v152, v136, v152, s[70:71]
    v_lshlrev_b32 v136, 3, v3
    v_sub_u32 v136, v136, v2
    s_waitcnt lgkmcnt(0)
    s_barrier
    ds_read_b32 v16, v141 offset:2052
    ds_read_b32 v17, v141 offset:2068
    ds_read_b128 v[8:11], v141 offset:4
    ds_read2_b32 v[12:13], v141 offset0:5 offset1:0
    s_mov_b64 exec, 0xffffffff
    ds_write_b128 v152, v[100:103]
    s_mov_b64 exec, -1
    buffer_load_dwordx4 v[104:107], v147, s[8:11], s22 offen sc0 sc1
    buffer_load_dwordx4 v[108:111], v147, s[8:11], s23 offen sc0 sc1
    v_add_u32 v136, 2031, v136
    v_and_b32 v137, 1, v136
    v_mul_u32_u24 v137, 4158, v137
    v_lshl_add_u32 v136, v136, 1, v137
    s_sub_u32 s37, s74, s54
    s_sub_u32 s37, s37, 704
    v_add_u32 v156, s37, v136
    v_subrev_u32 v157, 1024, v156
    v_subrev_u32 v158, 1024, v157
    v_subrev_u32 v159, 1024, v158
    v_lshlrev_b32 v151, 5, v2
    v_lshl_add_u32 v151, v3, 4, v151
    s_add_u32 s37, s32, 288
    s_sub_u32 s37, s37, s54
    s_waitcnt lgkmcnt(3)
    v_perm_b32 v20, v17, v17, s35
    v_perm_b32 v21, v16, v17, v142
    v_perm_b32 v22, v16, v16, s35
    v_mov_b32 v23, v22
    v_mov_b32 v28, v20
    v_alignbit_b32 v29, v22, v21, 16
    v_mov_b32 v30, v22
    v_mov_b32 v31, v22
    ds_write_b128 v146, v[20:23]
    ds_write_b128 v146, v[28:31] offset:4160
    s_waitcnt lgkmcnt(3)
    v_lshrrev_b32 v13, 16, v13
    v_cndmask_b32 v13, v8, v13, s[72:73]
    v_cndmask_b32 v9, v9, v8, s[70:71]
    v_perm_b32 v24, v12, v11, v143
    v_perm_b32 v25, v10, v10, v144
    v_perm_b32 v26, v10, v9, v145
    v_perm_b32 v27, v8, v8, v144
    v_alignbit_b32 v32, v25, v24, 16
    v_alignbit_b32 v33, v26, v25, 16
    v_alignbit_b32 v34, v27, v26, 16
    v_alignbit_b32 v35, v13, v27, 16
    ds_write_b128 v146, v[24:27] offset:2048
    ds_write_b128 v146, v[32:35] offset:6208
    v_add_u32 v151, s37, v151
    v_bfe_u32 v136, v2, 1, 2
    v_xor_b32 v136, v136, v3
    v_lshl_add_u32 v136, v2, 2, v136
    s_lshl_b32 s40, s39, 14
    s_lshl_b32 s41, s38, 13
    s_add_u32 s40, s40, s41
    v_lshl_add_u32 v153, v136, 4, s40
    s_lshl_b32 s41, s20, 6
    s_add_u32 s41, s41, 0x900000
    s_add_u32 s42, s41, 1105920
    s_mov_b32 s62, 0
    s_waitcnt vmcnt(0)
    v_xor_b32 v104, v4, v104
    v_xor_b32 v105, v5, v105
    v_xor_b32 v106, v6, v106
    v_xor_b32 v107, v7, v107
    v_xor_b32 v108, v4, v108
    v_xor_b32 v109, v5, v109
    v_xor_b32 v110, v6, v110
    v_xor_b32 v111, v7, v111
    v_or3_b32 v136, v104, v105, v106
    v_or3_b32 v136, v136, v107, v108
    v_or3_b32 v136, v136, v109, v110
    v_or_b32 v136, v136, v111
    v_and_b32 v136, s61, v136
    v_cmp_ne_u32 vcc, 0, v136
    s_nop 0
    s_cbranch_vccnz LP6
LP6_ok:
    ds_write_b128 v148, v[104:107] offset:512
    ds_write_b128 v148, v[108:111] offset:1536
    s_waitcnt lgkmcnt(0)
    s_barrier
    ds_read_b128 v[40:43], v151 offset:192
    ds_read2_b32 v[36:37], v159 offset0:48 offset1:49
    ds_read2_b32 v[38:39], v159 offset0:50 offset1:51
    ds_read2_b32 v[32:33], v159 offset0:176 offset1:177
    ds_read2_b32 v[34:35], v159 offset0:178 offset1:179
    ds_read_b128 v[44:47], v151 offset:704
    ds_read2_b32 v[28:29], v158 offset0:48 offset1:49
    ds_read2_b32 v[30:31], v158 offset0:50 offset1:51
    ds_read_b128 v[48:51], v151 offset:1216
    ds_read2_b32 v[24:25], v158 offset0:176 offset1:177
    ds_read2_b32 v[26:27], v158 offset0:178 offset1:179
    ds_read_b128 v[52:55], v151 offset:1728
    s_waitcnt lgkmcnt(9)
    v_mfma_f32_16x16x32_bf16 v[100:103], v[36:39], v[40:43], 0
    ds_read2_b32 v[20:21], v157 offset0:48 offset1:49
    s_waitcnt lgkmcnt(8)
    v_mfma_f32_16x16x32_bf16 v[96:99], v[32:35], v[40:43], 0
    ds_read2_b32 v[22:23], v157 offset0:50 offset1:51
    s_waitcnt lgkmcnt(8)
    v_mfma_f32_16x16x32_bf16 v[100:103], v[32:35], v[44:47], v[100:103]
    ds_read_b128 v[56:59], v151 offset:2240
    s_waitcnt lgkmcnt(7)
    v_mfma_f32_16x16x32_bf16 v[92:95], v[28:31], v[40:43], 0
    ds_read2_b32 v[16:17], v157 offset0:176 offset1:177
    v_mfma_f32_16x16x32_bf16 v[96:99], v[28:31], v[44:47], v[96:99]
    ds_read2_b32 v[18:19], v157 offset0:178 offset1:179
    s_waitcnt lgkmcnt(8)
    v_mfma_f32_16x16x32_bf16 v[100:103], v[28:31], v[48:51], v[100:103]
    ds_read_b128 v[60:63], v151 offset:2752
    s_waitcnt lgkmcnt(7)
    v_mfma_f32_16x16x32_bf16 v[88:91], v[24:27], v[40:43], 0
    ds_read2_b32 v[12:13], v156 offset0:48 offset1:49
    v_mfma_f32_16x16x32_bf16 v[92:95], v[24:27], v[44:47], v[92:95]
    ds_read2_b32 v[14:15], v156 offset0:50 offset1:51
    v_mfma_f32_16x16x32_bf16 v[96:99], v[24:27], v[48:51], v[96:99]
    ds_read_b128 v[64:67], v151 offset:3264
    s_waitcnt lgkmcnt(9)
    v_mfma_f32_16x16x32_bf16 v[100:103], v[24:27], v[52:55], v[100:103]
    ds_read2_b32 v[8:9], v156 offset0:176 offset1:177
    s_waitcnt lgkmcnt(8)
    v_mfma_f32_16x16x32_bf16 v[84:87], v[20:23], v[40:43], 0
    ds_read2_b32 v[10:11], v156 offset0:178 offset1:179
    v_mfma_f32_16x16x32_bf16 v[88:91], v[20:23], v[44:47], v[88:91]
    ds_read_b128 v[68:71], v151 offset:3776
    v_mfma_f32_16x16x32_bf16 v[92:95], v[20:23], v[48:51], v[92:95]
    ds_read_b128 v[104:107], v151 offset:128
    v_mfma_f32_16x16x32_bf16 v[96:99], v[20:23], v[52:55], v[96:99]
    ds_read2_b32 v[36:37], v159 offset0:32 offset1:33
    s_waitcnt lgkmcnt(11)
    v_mfma_f32_16x16x32_bf16 v[100:103], v[20:23], v[56:59], v[100:103]
    ds_read2_b32 v[38:39], v159 offset0:34 offset1:35
    s_waitcnt lgkmcnt(10)
    v_mfma_f32_16x16x32_bf16 v[80:83], v[16:19], v[40:43], 0
    ds_read2_b32 v[32:33], v159 offset0:160 offset1:161
    v_mfma_f32_16x16x32_bf16 v[84:87], v[16:19], v[44:47], v[84:87]
    ds_read2_b32 v[34:35], v159 offset0:162 offset1:163
    v_mfma_f32_16x16x32_bf16 v[88:91], v[16:19], v[48:51], v[88:91]
    ds_read_b128 v[108:111], v151 offset:640
    v_mfma_f32_16x16x32_bf16 v[92:95], v[16:19], v[52:55], v[92:95]
    ds_read2_b32 v[28:29], v158 offset0:32 offset1:33
    v_mfma_f32_16x16x32_bf16 v[96:99], v[16:19], v[56:59], v[96:99]
    ds_read2_b32 v[30:31], v158 offset0:34 offset1:35
    s_waitcnt lgkmcnt(14)
    v_mfma_f32_16x16x32_bf16 v[100:103], v[16:19], v[60:63], v[100:103]
    ds_read_b128 v[112:115], v151 offset:1152
    s_waitcnt lgkmcnt(13)
    v_mfma_f32_16x16x32_bf16 v[76:79], v[12:15], v[40:43], 0
    ds_read2_b32 v[24:25], v158 offset0:160 offset1:161
    v_mfma_f32_16x16x32_bf16 v[80:83], v[12:15], v[44:47], v[80:83]
    ds_read2_b32 v[26:27], v158 offset0:162 offset1:163
    v_mfma_f32_16x16x32_bf16 v[84:87], v[12:15], v[48:51], v[84:87]
    ds_read_b128 v[116:119], v151 offset:1664
    v_mfma_f32_16x16x32_bf16 v[88:91], v[12:15], v[52:55], v[88:91]
    ds_read2_b32 v[20:21], v157 offset0:32 offset1:33
    v_mfma_f32_16x16x32_bf16 v[92:95], v[12:15], v[56:59], v[92:95]
    ds_read2_b32 v[22:23], v157 offset0:34 offset1:35
    v_mfma_f32_16x16x32_bf16 v[96:99], v[12:15], v[60:63], v[96:99]
    ds_read_b128 v[120:123], v151 offset:2176
    s_waitcnt lgkmcnt(15)
    v_mfma_f32_16x16x32_bf16 v[100:103], v[12:15], v[64:67], v[100:103]
    ds_read2_b32 v[16:17], v157 offset0:160 offset1:161
    v_mfma_f32_16x16x32_bf16 v[72:75], v[8:11], v[40:43], 0
    ds_read2_b32 v[18:19], v157 offset0:162 offset1:163
    v_mfma_f32_16x16x32_bf16 v[76:79], v[8:11], v[44:47], v[76:79]
    ds_read_b128 v[124:127], v151 offset:2688
    v_mfma_f32_16x16x32_bf16 v[80:83], v[8:11], v[48:51], v[80:83]
    ds_read2_b32 v[12:13], v156 offset0:32 offset1:33
    v_mfma_f32_16x16x32_bf16 v[84:87], v[8:11], v[52:55], v[84:87]
    ds_read2_b32 v[14:15], v156 offset0:34 offset1:35
    v_mfma_f32_16x16x32_bf16 v[88:91], v[8:11], v[56:59], v[88:91]
    ds_read_b128 v[128:131], v151 offset:3200
    v_mfma_f32_16x16x32_bf16 v[92:95], v[8:11], v[60:63], v[92:95]
    ds_read_b128 v[132:135], v151 offset:3712
    v_mfma_f32_16x16x32_bf16 v[96:99], v[8:11], v[64:67], v[96:99]
    ds_read_b128 v[40:43], v151 offset:64
    v_mfma_f32_16x16x32_bf16 v[100:103], v[8:11], v[68:71], v[100:103]
    ds_read2_b32 v[8:9], v156 offset0:160 offset1:161
    s_waitcnt lgkmcnt(15)
    v_mfma_f32_16x16x32_bf16 v[100:103], v[36:39], v[104:107], v[100:103]
    ds_read2_b32 v[10:11], v156 offset0:162 offset1:163
    v_mfma_f32_16x16x32_bf16 v[96:99], v[32:35], v[104:107], v[96:99]
    ds_read2_b32 v[36:37], v159 offset0:16 offset1:17
    v_mfma_f32_16x16x32_bf16 v[100:103], v[32:35], v[108:111], v[100:103]
    ds_read2_b32 v[38:39], v159 offset0:18 offset1:19
    v_mfma_f32_16x16x32_bf16 v[92:95], v[28:31], v[104:107], v[92:95]
    ds_read2_b32 v[32:33], v159 offset0:144 offset1:145
    v_mfma_f32_16x16x32_bf16 v[96:99], v[28:31], v[108:111], v[96:99]
    ds_read2_b32 v[34:35], v159 offset0:146 offset1:147
    v_mfma_f32_16x16x32_bf16 v[100:103], v[28:31], v[112:115], v[100:103]
    ds_read_b128 v[44:47], v151 offset:576
    s_waitcnt lgkmcnt(15)
    v_mfma_f32_16x16x32_bf16 v[88:91], v[24:27], v[104:107], v[88:91]
    ds_read2_b32 v[28:29], v158 offset0:16 offset1:17
    v_mfma_f32_16x16x32_bf16 v[92:95], v[24:27], v[108:111], v[92:95]
    ds_read2_b32 v[30:31], v158 offset0:18 offset1:19
    v_mfma_f32_16x16x32_bf16 v[96:99], v[24:27], v[112:115], v[96:99]
    ds_read_b128 v[48:51], v151 offset:1088
    v_mfma_f32_16x16x32_bf16 v[100:103], v[24:27], v[116:119], v[100:103]
    ds_read2_b32 v[24:25], v158 offset0:144 offset1:145
    v_mfma_f32_16x16x32_bf16 v[84:87], v[20:23], v[104:107], v[84:87]
    ds_read2_b32 v[26:27], v158 offset0:146 offset1:147
    v_mfma_f32_16x16x32_bf16 v[88:91], v[20:23], v[108:111], v[88:91]
    ds_read_b128 v[52:55], v151 offset:1600
    v_mfma_f32_16x16x32_bf16 v[92:95], v[20:23], v[112:115], v[92:95]
    ds_read_b128 v[56:59], v151 offset:2112
    v_mfma_f32_16x16x32_bf16 v[96:99], v[20:23], v[116:119], v[96:99]
    ds_read_b128 v[60:63], v151 offset:2624
    v_mfma_f32_16x16x32_bf16 v[100:103], v[20:23], v[120:123], v[100:103]
    ds_read2_b32 v[20:21], v157 offset0:16 offset1:17
    s_waitcnt lgkmcnt(15)
    v_mfma_f32_16x16x32_bf16 v[80:83], v[16:19], v[104:107], v[80:83]
    ds_read2_b32 v[22:23], v157 offset0:18 offset1:19
    v_mfma_f32_16x16x32_bf16 v[84:87], v[16:19], v[108:111], v[84:87]
    ds_read_b128 v[64:67], v151 offset:3136
    v_mfma_f32_16x16x32_bf16 v[88:91], v[16:19], v[112:115], v[88:91]
    ds_read_b128 v[68:71], v151 offset:3648
    v_mfma_f32_16x16x32_bf16 v[92:95], v[16:19], v[116:119], v[92:95]
    v_mfma_f32_16x16x32_bf16 v[96:99], v[16:19], v[120:123], v[96:99]
    v_mfma_f32_16x16x32_bf16 v[100:103], v[16:19], v[124:127], v[100:103]
    ds_read2_b32 v[16:17], v157 offset0:144 offset1:145
    v_mfma_f32_16x16x32_bf16 v[76:79], v[12:15], v[104:107], v[76:79]
    ds_read2_b32 v[18:19], v157 offset0:146 offset1:147
    v_mfma_f32_16x16x32_bf16 v[80:83], v[12:15], v[108:111], v[80:83]
    v_mfma_f32_16x16x32_bf16 v[84:87], v[12:15], v[112:115], v[84:87]
    v_mfma_f32_16x16x32_bf16 v[88:91], v[12:15], v[116:119], v[88:91]
    v_mfma_f32_16x16x32_bf16 v[92:95], v[12:15], v[120:123], v[92:95]
    v_mfma_f32_16x16x32_bf16 v[96:99], v[12:15], v[124:127], v[96:99]
    v_mfma_f32_16x16x32_bf16 v[100:103], v[12:15], v[128:131], v[100:103]
    ds_read2_b32 v[12:13], v156 offset0:16 offset1:17
    s_waitcnt lgkmcnt(15)
    v_mfma_f32_16x16x32_bf16 v[72:75], v[8:11], v[104:107], v[72:75]
    ds_read2_b32 v[14:15], v156 offset0:18 offset1:19
    v_mfma_f32_16x16x32_bf16 v[76:79], v[8:11], v[108:111], v[76:79]
    ds_read_b128 v[104:107], v151 offset:0
    v_mfma_f32_16x16x32_bf16 v[80:83], v[8:11], v[112:115], v[80:83]
    ds_read_b128 v[108:111], v151 offset:512
    v_mfma_f32_16x16x32_bf16 v[84:87], v[8:11], v[116:119], v[84:87]
    ds_read_b128 v[112:115], v151 offset:1024
    v_mfma_f32_16x16x32_bf16 v[88:91], v[8:11], v[120:123], v[88:91]
    ds_read_b128 v[116:119], v151 offset:1536
    v_mfma_f32_16x16x32_bf16 v[92:95], v[8:11], v[124:127], v[92:95]
    ds_read_b128 v[120:123], v151 offset:2048
    v_mfma_f32_16x16x32_bf16 v[96:99], v[8:11], v[128:131], v[96:99]
    ds_read_b128 v[124:127], v151 offset:2560
    v_mfma_f32_16x16x32_bf16 v[100:103], v[8:11], v[132:135], v[100:103]
    ds_read2_b32 v[8:9], v156 offset0:144 offset1:145
    v_mfma_f32_16x16x32_bf16 v[100:103], v[36:39], v[40:43], v[100:103]
    ds_read2_b32 v[10:11], v156 offset0:146 offset1:147
    v_mfma_f32_16x16x32_bf16 v[96:99], v[32:35], v[40:43], v[96:99]
    ds_read2_b32 v[36:37], v159 offset0:0 offset1:1
    v_mfma_f32_16x16x32_bf16 v[100:103], v[32:35], v[44:47], v[100:103]
    ds_read2_b32 v[38:39], v159 offset0:2 offset1:3
    s_waitcnt lgkmcnt(15)
    v_mfma_f32_16x16x32_bf16 v[92:95], v[28:31], v[40:43], v[92:95]
    ds_read2_b32 v[32:33], v159 offset0:128 offset1:129
    v_mfma_f32_16x16x32_bf16 v[96:99], v[28:31], v[44:47], v[96:99]
    ds_read2_b32 v[34:35], v159 offset0:130 offset1:131
    v_mfma_f32_16x16x32_bf16 v[100:103], v[28:31], v[48:51], v[100:103]
    ds_read2_b32 v[28:29], v158 offset0:0 offset1:1
    v_mfma_f32_16x16x32_bf16 v[88:91], v[24:27], v[40:43], v[88:91]
    ds_read2_b32 v[30:31], v158 offset0:2 offset1:3
    v_mfma_f32_16x16x32_bf16 v[92:95], v[24:27], v[44:47], v[92:95]
    ds_read_b128 v[128:131], v151 offset:3072
    v_mfma_f32_16x16x32_bf16 v[96:99], v[24:27], v[48:51], v[96:99]
    ds_read_b128 v[132:135], v151 offset:3584
    v_mfma_f32_16x16x32_bf16 v[100:103], v[24:27], v[52:55], v[100:103]
    ds_read2_b32 v[24:25], v158 offset0:128 offset1:129
    v_mfma_f32_16x16x32_bf16 v[84:87], v[20:23], v[40:43], v[84:87]
    ds_read2_b32 v[26:27], v158 offset0:130 offset1:131
    v_mfma_f32_16x16x32_bf16 v[88:91], v[20:23], v[44:47], v[88:91]
    v_mfma_f32_16x16x32_bf16 v[92:95], v[20:23], v[48:51], v[92:95]
    v_mfma_f32_16x16x32_bf16 v[96:99], v[20:23], v[52:55], v[96:99]
    v_mfma_f32_16x16x32_bf16 v[100:103], v[20:23], v[56:59], v[100:103]
    ds_read2_b32 v[20:21], v157 offset0:0 offset1:1
    s_waitcnt lgkmcnt(15)
    v_mfma_f32_16x16x32_bf16 v[80:83], v[16:19], v[40:43], v[80:83]
    ds_read2_b32 v[22:23], v157 offset0:2 offset1:3
    v_mfma_f32_16x16x32_bf16 v[84:87], v[16:19], v[44:47], v[84:87]
    v_mfma_f32_16x16x32_bf16 v[88:91], v[16:19], v[48:51], v[88:91]
    v_mfma_f32_16x16x32_bf16 v[92:95], v[16:19], v[52:55], v[92:95]
    v_mfma_f32_16x16x32_bf16 v[96:99], v[16:19], v[56:59], v[96:99]
    v_mfma_f32_16x16x32_bf16 v[100:103], v[16:19], v[60:63], v[100:103]
    ds_read2_b32 v[16:17], v157 offset0:128 offset1:129
    v_mfma_f32_16x16x32_bf16 v[76:79], v[12:15], v[40:43], v[76:79]
    ds_read2_b32 v[18:19], v157 offset0:130 offset1:131
    v_mfma_f32_16x16x32_bf16 v[80:83], v[12:15], v[44:47], v[80:83]
    v_mfma_f32_16x16x32_bf16 v[84:87], v[12:15], v[48:51], v[84:87]
    v_mfma_f32_16x16x32_bf16 v[88:91], v[12:15], v[52:55], v[88:91]
    v_mfma_f32_16x16x32_bf16 v[92:95], v[12:15], v[56:59], v[92:95]
    v_mfma_f32_16x16x32_bf16 v[96:99], v[12:15], v[60:63], v[96:99]
    v_mfma_f32_16x16x32_bf16 v[100:103], v[12:15], v[64:67], v[100:103]
    ds_read2_b32 v[12:13], v156 offset0:0 offset1:1
    s_waitcnt lgkmcnt(15)
    v_mfma_f32_16x16x32_bf16 v[72:75], v[8:11], v[40:43], v[72:75]
    ds_read2_b32 v[14:15], v156 offset0:2 offset1:3
    v_mfma_f32_16x16x32_bf16 v[76:79], v[8:11], v[44:47], v[76:79]
    v_mfma_f32_16x16x32_bf16 v[80:83], v[8:11], v[48:51], v[80:83]
    v_mfma_f32_16x16x32_bf16 v[84:87], v[8:11], v[52:55], v[84:87]
    v_mfma_f32_16x16x32_bf16 v[88:91], v[8:11], v[56:59], v[88:91]
    v_mfma_f32_16x16x32_bf16 v[92:95], v[8:11], v[60:63], v[92:95]
    v_mfma_f32_16x16x32_bf16 v[96:99], v[8:11], v[64:67], v[96:99]
    v_mfma_f32_16x16x32_bf16 v[100:103], v[8:11], v[68:71], v[100:103]
    ds_read2_b32 v[8:9], v156 offset0:128 offset1:129
    s_waitcnt lgkmcnt(15)
    v_mfma_f32_16x16x32_bf16 v[100:103], v[36:39], v[104:107], v[100:103]
    ds_read2_b32 v[10:11], v156 offset0:130 offset1:131
    s_waitcnt lgkmcnt(14)
    v_mfma_f32_16x16x32_bf16 v[100:103], v[32:35], v[108:111], v[100:103]
    s_waitcnt lgkmcnt(12)
    v_mfma_f32_16x16x32_bf16 v[100:103], v[28:31], v[112:115], v[100:103]
    s_waitcnt lgkmcnt(8)
    v_mfma_f32_16x16x32_bf16 v[100:103], v[24:27], v[116:119], v[100:103]
    s_waitcnt lgkmcnt(6)
    v_mfma_f32_16x16x32_bf16 v[100:103], v[20:23], v[120:123], v[100:103]
    s_waitcnt lgkmcnt(4)
    v_mfma_f32_16x16x32_bf16 v[100:103], v[16:19], v[124:127], v[100:103]
    s_waitcnt lgkmcnt(2)
    v_mfma_f32_16x16x32_bf16 v[100:103], v[12:15], v[128:131], v[100:103]
    s_waitcnt lgkmcnt(0)
    v_mfma_f32_16x16x32_bf16 v[100:103], v[8:11], v[132:135], v[100:103]
    s_barrier
    v_mfma_f32_16x16x32_bf16 v[96:99], v[32:35], v[104:107], v[96:99]
    v_mfma_f32_16x16x32_bf16 v[96:99], v[28:31], v[108:111], v[96:99]
    v_mfma_f32_16x16x32_bf16 v[96:99], v[24:27], v[112:115], v[96:99]
    s_nop 3
    ds_write_b128 v153, v[100:103] offset:7168
    v_mfma_f32_16x16x32_bf16 v[96:99], v[20:23], v[116:119], v[96:99]
    v_mfma_f32_16x16x32_bf16 v[96:99], v[16:19], v[120:123], v[96:99]
    v_mfma_f32_16x16x32_bf16 v[96:99], v[12:15], v[124:127], v[96:99]
    v_mfma_f32_16x16x32_bf16 v[96:99], v[8:11], v[128:131], v[96:99]
    v_mfma_f32_16x16x32_bf16 v[92:95], v[28:31], v[104:107], v[92:95]
    v_mfma_f32_16x16x32_bf16 v[92:95], v[24:27], v[108:111], v[92:95]
    v_mfma_f32_16x16x32_bf16 v[92:95], v[20:23], v[112:115], v[92:95]
    s_nop 4
    ds_write_b128 v153, v[96:99] offset:6144
    v_mfma_f32_16x16x32_bf16 v[92:95], v[16:19], v[116:119], v[92:95]
    v_mfma_f32_16x16x32_bf16 v[92:95], v[12:15], v[120:123], v[92:95]
    v_mfma_f32_16x16x32_bf16 v[92:95], v[8:11], v[124:127], v[92:95]
    v_mfma_f32_16x16x32_bf16 v[88:91], v[24:27], v[104:107], v[88:91]
    v_mfma_f32_16x16x32_bf16 v[88:91], v[20:23], v[108:111], v[88:91]
    v_mfma_f32_16x16x32_bf16 v[88:91], v[16:19], v[112:115], v[88:91]
    s_nop 4
    ds_write_b128 v153, v[92:95] offset:5120
    v_mfma_f32_16x16x32_bf16 v[88:91], v[12:15], v[116:119], v[88:91]
    v_mfma_f32_16x16x32_bf16 v[88:91], v[8:11], v[120:123], v[88:91]
    v_mfma_f32_16x16x32_bf16 v[84:87], v[20:23], v[104:107], v[84:87]
    v_mfma_f32_16x16x32_bf16 v[84:87], v[16:19], v[108:111], v[84:87]
    v_mfma_f32_16x16x32_bf16 v[84:87], v[12:15], v[112:115], v[84:87]
    s_nop 4
    ds_write_b128 v153, v[88:91] offset:4096
    v_mfma_f32_16x16x32_bf16 v[84:87], v[8:11], v[116:119], v[84:87]
    v_mfma_f32_16x16x32_bf16 v[80:83], v[16:19], v[104:107], v[80:83]
    v_mfma_f32_16x16x32_bf16 v[80:83], v[12:15], v[108:111], v[80:83]
    v_mfma_f32_16x16x32_bf16 v[80:83], v[8:11], v[112:115], v[80:83]
    s_nop 4
    ds_write_b128 v153, v[84:87] offset:3072
    v_mfma_f32_16x16x32_bf16 v[76:79], v[12:15], v[104:107], v[76:79]
    v_mfma_f32_16x16x32_bf16 v[76:79], v[8:11], v[108:111], v[76:79]
    v_mfma_f32_16x16x32_bf16 v[72:75], v[8:11], v[104:107], v[72:75]
    ds_write_b128 v153, v[80:83] offset:2048
    s_nop 5
    ds_write_b128 v153, v[76:79] offset:1024
    ds_write_b128 v153, v[72:75] offset:0
    s_waitcnt lgkmcnt(0)
    s_barrier
    ds_read_b64 v[8:9], v154 offset:0
    ds_read_b64 v[10:11], v154 offset:16384
    ds_read_b64 v[12:13], v154 offset:8192
    ds_read_b64 v[14:15], v154 offset:24576
    ds_read_b64 v[16:17], v154 offset:4096
    ds_read_b64 v[18:19], v154 offset:20480
    ds_read_b64 v[20:21], v154 offset:12288
    ds_read_b64 v[22:23], v154 offset:28672
    ds_read_b64 v[24:25], v154 offset:2048
    ds_read_b64 v[26:27], v154 offset:18432
    ds_read_b64 v[28:29], v154 offset:10240
    ds_read_b64 v[30:31], v154 offset:26624
    ds_read_b64 v[32:33], v154 offset:6144
    ds_read_b64 v[34:35], v154 offset:22528
    ds_read_b64 v[36:37], v154 offset:14336
    ds_read_b64 v[38:39], v154 offset:30720
    s_waitcnt lgkmcnt(8)
    v_pk_add_f32 v[8:9], v[8:9], v[10:11]
    v_pk_add_f32 v[12:13], v[12:13], v[14:15]
    v_pk_add_f32 v[16:17], v[16:17], v[18:19]
    v_pk_add_f32 v[20:21], v[20:21], v[22:23]
    v_cvt_pk_bf16_f32 v72, v8, v12
    v_cvt_pk_bf16_f32 v73, v16, v20
    v_cvt_pk_bf16_f32 v74, v9, v13
    v_cvt_pk_bf16_f32 v75, v17, v21
    v_bfi_b32 v72, s61, v4, v72
    v_bfi_b32 v73, s61, v5, v73
    v_bfi_b32 v74, s61, v6, v74
    v_bfi_b32 v75, s61, v7, v75
    buffer_store_dwordx4 v[72:75], v155, s[8:11], s41 offen sc0 sc1
    s_waitcnt lgkmcnt(0)
    v_pk_add_f32 v[24:25], v[24:25], v[26:27]
    v_pk_add_f32 v[28:29], v[28:29], v[30:31]
    v_pk_add_f32 v[32:33], v[32:33], v[34:35]
    v_pk_add_f32 v[36:37], v[36:37], v[38:39]
    v_cvt_pk_bf16_f32 v76, v24, v28
    v_cvt_pk_bf16_f32 v77, v32, v36
    v_cvt_pk_bf16_f32 v78, v25, v29
    v_cvt_pk_bf16_f32 v79, v33, v37
    v_bfi_b32 v76, s61, v4, v76
    v_bfi_b32 v77, s61, v5, v77
    v_bfi_b32 v78, s61, v6, v78
    v_bfi_b32 v79, s61, v7, v79
    buffer_store_dwordx4 v[76:79], v155, s[8:11], s42 offen sc0 sc1
    s_endpgm
LP6:
LP6_e:
    s_wqm_b64 exec, vcc
    buffer_load_dwordx4 v[104:107], v147, s[8:11], s22 offen sc0 sc1
    buffer_load_dwordx4 v[108:111], v147, s[8:11], s23 offen sc0 sc1
LP6_w:
    s_waitcnt vmcnt(0)
    v_xor_b32 v104, v4, v104
    v_xor_b32 v105, v5, v105
    v_xor_b32 v106, v6, v106
    v_xor_b32 v107, v7, v107
    v_xor_b32 v108, v4, v108
    v_xor_b32 v109, v5, v109
    v_xor_b32 v110, v6, v110
    v_xor_b32 v111, v7, v111
    v_or3_b32 v136, v104, v105, v106
    v_or3_b32 v136, v136, v107, v108
    v_or3_b32 v136, v136, v109, v110
    v_or_b32 v136, v136, v111
    v_and_b32 v136, s61, v136
    v_cmp_ne_u32 vcc, 0, v136
    s_add_u32 s62, s62, 1
    s_cmp_lt_u32 s62, 65536
    s_cselect_b64 vcc, vcc, 0
    s_cbranch_vccnz LP6
    s_mov_b64 exec, -1
    s_branch LP6_ok
L_exit:
    s_endpgm

.section .rodata,"a"
.p2align 6
.amdhsa_kernel gated_mix__ssm_conv_s4d__spectral_gfnet__prompt_kernel
  .amdhsa_next_free_vgpr 164
  .amdhsa_next_free_sgpr 75
  .amdhsa_accum_offset 164
  .amdhsa_group_segment_fixed_size 0
  .amdhsa_kernarg_size 112
  .amdhsa_user_sgpr_count 2
  .amdhsa_user_sgpr_kernarg_segment_ptr 1
  .amdhsa_system_sgpr_workgroup_id_x 1
.end_amdhsa_kernel
```
